```python
import torch

def _softmax(x, axis=-1):
    return torch.softmax(x, dim=axis)
def _gelu(x):
    return torch.nn.functional.gelu(x, approximate="tanh")
def _silu(x):
    return torch.nn.functional.silu(x)
def _sigmoid(x):
    return torch.sigmoid(x)
def _layernorm(x, axis=-1, eps=1e-5):
    m = x.mean(dim=axis, keepdim=True)
    v = x.var(dim=axis, keepdim=True, unbiased=False)
    return (x - m) / torch.sqrt(v + eps)
def _scatter_add(tgt, idx, src, axis=0):
    return tgt.clone().index_add_(axis, idx, src)
def _segment_sum(src, seg, n):
    out = torch.zeros((n,) + src.shape[1:], dtype=src.dtype)
    return out.index_add_(0, seg, src)
def _pad(x, pw):
    flat = tuple(v for pair in reversed(pw) for v in pair)
    return torch.nn.functional.pad(x, flat)

kernel_name = 'recurrent_scan__sliding_block_cached__mixer_channel_mlp__decode'

def setup_inputs():

    _w = (lambda a: (lambda t: t.to(torch.bfloat16) if t.is_floating_point() else t)(torch.as_tensor(a)))
    def _A_setup():
        B, Sq, D = 4, 1, 512
        Hq, Hkv, Sk, Dh = 32, 8, 8192, 128
        assert Hq % Hkv == 0, (Hq, Hkv)
        return {
            "x": _w((lambda *s: torch.randn(*s, dtype=torch.bfloat16) * 0.05)(B, Sq, D)),
            "k_cache": _w((lambda *s: torch.randn(*s, dtype=torch.bfloat16) * 3.2)(B, Hkv, Sk, Dh)),
            "v_cache": _w((lambda *s: torch.randn(*s, dtype=torch.bfloat16) * 3.2)(B, Hkv, Sk, Dh)),
            "wq": _w((lambda *s: torch.randn(*s, dtype=torch.bfloat16) * 3.2)(D, Hq * Dh) * (D ** -0.5)),
            "wo": _w((lambda *s: torch.randn(*s, dtype=torch.bfloat16) * 3.2)(Hq * Dh, D) * ((Hq * Dh) ** -0.5)),
        }
    _A_in = _A_setup()

    def _B_setup():
        B, S, D, F = 4, 1, 512, 1792
        return {
            "x": _w((lambda *s: torch.randn(*s, dtype=torch.bfloat16) * 0.05)(B, S, D)),
            "w1": _w((lambda *s: torch.randn(*s, dtype=torch.bfloat16) * 3.2)(D, F) * (D ** -0.5)),
            "b1": _w((lambda *s: torch.randn(*s, dtype=torch.bfloat16) * 3.2)(F)),
            "w2": _w((lambda *s: torch.randn(*s, dtype=torch.bfloat16) * 3.2)(F, D) * (F ** -0.5)),
            "b2": _w((lambda *s: torch.randn(*s, dtype=torch.bfloat16) * 3.2)(D)),
        }
    _B_in = _B_setup()

    return {
        "A_x": _A_in["x"],
        "A_k_cache": _A_in["k_cache"],
        "A_v_cache": _A_in["v_cache"],
        "A_wq": _A_in["wq"],
        "A_wo": _A_in["wo"],
        "B_x": _B_in["x"],
        "B_w1": _B_in["w1"],
        "B_b1": _B_in["b1"],
        "B_w2": _B_in["w2"],
        "B_b2": _B_in["b2"],
    }

def reference(A_x, A_k_cache, A_v_cache, A_wq, A_wo, B_x, B_w1, B_b1, B_w2, B_b2):
    def _A_ref(x, k_cache, v_cache, wq, wo):
        B, Sq, D = x.shape
        Hq, Dh = 32, 128
        Hkv, Sk = k_cache.shape[1], k_cache.shape[2]
        W = min(4096, max(256, Sk // 4))
        rep = Hq // Hkv
        q = (lambda x, *d: x.permute(*d))((x @ wq).reshape(B, Sq, Hq, Dh), 0, 2, 1, 3)
        k = (lambda x, n, axis: torch.repeat_interleave(x, n, dim=axis))(k_cache[:, :, Sk - W:, :], rep, axis=1)
        v = (lambda x, n, axis: torch.repeat_interleave(x, n, dim=axis))(v_cache[:, :, Sk - W:, :], rep, axis=1)
        scores = torch.einsum("bhqd,bhkd->bhqk", q, k) * (Dh ** -0.5)
        p = _softmax(scores, axis=-1)
        o = torch.einsum("bhqk,bhkd->bhqd", p, v)
        return (lambda x, *d: x.permute(*d))(o, 0, 2, 1, 3).reshape(B, Sq, Hq * Dh) @ wo

    def _B_ref(x, w1, b1, w2, b2):
        y = _layernorm(x, axis=-1)
        h = _gelu(torch.einsum("bsd,df->bsf", y, w1) + b1)
        return torch.einsum("bsf,fd->bsd", h, w2) + b2

    x = A_x
    xn = _layernorm(x, axis=-1)
    s = _A_ref(xn, A_k_cache, A_v_cache, A_wq, A_wo)
    g = _silu(_B_ref(xn, B_w1, B_b1, B_w2, B_b2))
    return x + s * g
```

```asm
; @launch grid=(256,1,1) block=(768,1,1) lds=130944
.amdgcn_target "amdgcn-amd-amdhsa--gfx950"
.text
.globl recurrent_scan__sliding_block_cached__mixer_channel_mlp__decode_kernel
.p2align 8
.type recurrent_scan__sliding_block_cached__mixer_channel_mlp__decode_kernel,@function
recurrent_scan__sliding_block_cached__mixer_channel_mlp__decode_kernel:
    s_cmp_ge_u32 s2, 256
    s_cbranch_scc1 L_end
    s_load_dwordx16 s[8:23], s[0:1], 0
    s_load_dwordx8 s[24:31], s[0:1], 64
    s_load_dwordx2 s[32:33], s[0:1], 96
    v_lshrrev_b32 v1, 6, v0
    v_and_b32 v0, 63, v0
    v_readfirstlane_b32 s3, v1
    s_getpc_b64 s[36:37]
L_pcref:
    s_sub_u32 s36, s36, L_pcref-recurrent_scan__sliding_block_cached__mixer_channel_mlp__decode_kernel
    s_subb_u32 s37, s37, 0
    s_lshr_b32 s38, s2, 3
    s_lshl_b32 s38, s38, 2
    s_and_b32 s39, s3, 3
    s_add_u32 s38, s38, s39
    s_lshl_b32 s38, s38, 7
    s_min_u32 s38, s38, L_end-recurrent_scan__sliding_block_cached__mixer_channel_mlp__decode_kernel
    v_mov_b32 v166, s38
    global_load_dword v166, v166, s[36:37]
    s_cmp_ge_u32 s3, 4
    s_cbranch_scc1 L_worker
L_helper:
    v_and_b32 v1, 15, v0
    v_lshrrev_b32 v2, 4, v0
    s_and_b32 s4, s2, 7
    s_bfe_u32 s5, s2, 0x30003
    s_lshr_b32 s6, s2, 6
    s_and_b32 s7, s2, 63
    v_mov_b32 v5, 130816
    v_mov_b32 v6, 1
    v_and_b32 v7, 31, v0
    v_lshlrev_b32 v7, 2, v7
    v_add_u32 v7, 130816, v7
    v_mov_b32 v8, 0
    s_cmp_lg_u32 s3, 0
    s_cbranch_scc1 L_noinit
    ds_write_b32 v7, v8
L_noinit:
    s_setprio 3
    s_lshl_b32 s35, s3, 10
    v_lshl_add_u32 v3, v0, 4, s35
    s_lshl_b32 s56, s6, 7
    s_lshl_b32 s57, s3, 5
    s_add_u32 s56, s56, s57
    s_lshl_b32 s56, s56, 13
    s_lshl_b32 s57, s4, 10
    s_add_u32 s56, s56, s57
    s_lshl_b32 s57, s5, 7
    s_add_u32 s56, s56, s57
    v_lshrrev_b32 v8, 3, v0
    v_and_b32 v9, 7, v0
    v_lshlrev_b32 v8, 13, v8
    v_lshl_add_u32 v8, v9, 4, v8
    s_lshl_b32 s35, s3, 12
    s_add_u32 s35, s35, 65536
    s_waitcnt lgkmcnt(0)
    global_load_dwordx4 v[12:15], v3, s[8:9]
    s_add_u32 s36, s14, s56
    s_addc_u32 s37, s15, 0
    s_and_b32 s37, s37, 0xffff
    s_mov_b32 s38, 254080
    s_mov_b32 s39, 0x20000
    s_add_u32 m0, s35, 0
    s_mov_b32 s30, 0
    buffer_load_dwordx4 v8, s[36:39], s30 offen nt lds
    s_add_u32 m0, s35, 1024
    s_mov_b32 s30, 65536
    buffer_load_dwordx4 v8, s[36:39], s30 offen nt lds
    s_add_u32 m0, s35, 2048
    s_mov_b32 s30, 131072
    buffer_load_dwordx4 v8, s[36:39], s30 offen nt lds
    s_add_u32 m0, s35, 3072
    s_mov_b32 s30, 196608
    buffer_load_dwordx4 v8, s[36:39], s30 offen nt lds
    s_barrier
    s_load_dword s34, s[32:33], 0
    s_bfe_u32 s31, s2, 0x20003
    s_bfe_u32 s35, s2, 0x10005
    s_lshl_b32 s35, s35, 4
    s_or_b32 s31, s31, s35
    s_cmp_gt_u32 s5, 3
    s_subb_u32 s0, s5, 0
    s_cmp_eq_u32 s5, 3
    s_cselect_b32 s0, 7, s0
    s_lshl_b32 s0, s0, 3
    s_add_u32 s0, s0, s4
    s_mul_i32 s1, s6, 56
    s_add_u32 s1, s1, s0
    v_add_u32 v3, 114688, v3
    v_lshrrev_b32 v8, 2, v1
    v_lshl_add_u32 v8, v2, 3, v8
    v_lshlrev_b32 v8, 7, v8
    v_and_b32 v9, 3, v1
    v_lshl_add_u32 v8, v9, 3, v8
    s_and_b32 s42, s3, 1
    s_lshl_b32 s35, s42, 6
    v_add_u32 v8, s35, v8
    v_bfe_u32 v11, v1, 2, 1
    v_and_b32 v155, 7, v0
    s_lshr_b32 s18, s7, 2
    s_lshl_b32 s18, s18, 6
    v_lshl_add_u32 v155, v155, 3, s18
    s_lshl_b32 s35, s6, 10
    v_add_u32 v154, s35, v155
    s_mov_b32 s40, 0xf0f0f0f0
    s_mov_b32 s41, 0xf0f0f0f0
    s_cmp_ge_u32 s3, 2
    s_cbranch_scc1 L_haddr
    v_add_u32 v8, 65536, v8
    s_lshr_b32 s19, s5, 1
    s_and_b32 s30, s5, 1
    s_lshl_b32 s35, s4, 15
    s_lshl_b32 s18, s19, 11
    s_add_u32 s35, s35, s18
    s_lshl_b32 s18, s6, 9
    s_add_u32 s35, s35, s18
    s_lshl_b32 s18, s30, 8
    s_add_u32 s35, s35, s18
    s_lshl_b32 s18, s42, 7
    s_add_u32 s35, s35, s18
    s_add_u32 s35, s35, 3670016
    v_lshlrev_b32 v10, 13, v9
    v_lshl_add_u32 v10, v2, 4, v10
    v_lshl_add_u32 v10, v11, 6, v10
    v_add_u32 v10, s35, v10
    s_lshl_b32 s35, s4, 11
    s_lshl_b32 s18, s19, 7
    s_add_u32 s35, s35, s18
    s_lshl_b32 s18, s6, 5
    s_add_u32 s35, s35, s18
    s_lshl_b32 s18, s30, 4
    s_add_u32 s35, s35, s18
    s_lshl_b32 s18, s42, 3
    s_add_u32 s35, s35, s18
    s_add_u32 s35, s35, 3932160
    v_lshl_add_u32 v11, v9, 9, s35
    v_lshlrev_b32 v9, 10, v9
    v_lshl_add_u32 v9, v2, 4, v9
    s_lshl_b32 s35, s6, 8
    s_add_u32 s35, s35, 114688
    v_add_u32 v9, s35, v9
    s_branch L_addr_done
L_haddr:
    v_add_u32 v8, 98304, v8
    s_mul_i32 s35, s1, 9363
    s_lshr_b32 s35, s35, 18
    s_mul_i32 s18, s35, 28
    s_sub_u32 s18, s1, s18
    s_lshl_b32 s18, s18, 1
    s_add_u32 s18, s18, s42
    s_lshl_b32 s19, s18, 12
    s_lshl_b32 s30, s35, 9
    s_add_u32 s19, s19, s30
    s_add_u32 s19, s19, 262144
    v_lshlrev_b32 v10, 7, v9
    v_lshl_add_u32 v10, v2, 4, v10
    v_lshl_add_u32 v10, v11, 6, v10
    v_add_u32 v10, s19, v10
    s_lshl_b32 s18, s18, 6
    s_lshl_b32 s30, s35, 2
    s_add_u32 s18, s18, s30
    s_add_u32 s18, s18, 524288
    v_mov_b32 v11, s18
    v_lshlrev_b32 v9, 10, v9
    v_lshl_add_u32 v9, v2, 4, v9
    s_lshl_b32 s19, s35, 7
    s_add_u32 s19, s19, 118784
    v_add_u32 v9, s19, v9
L_addr_done:
    s_mov_b32 s94, 0
    s_waitcnt vmcnt(4)
L_ln:
    v_lshlrev_b32 v16, 16, v12
    v_and_b32 v17, 0xffff0000, v12
    v_lshlrev_b32 v18, 16, v13
    v_and_b32 v19, 0xffff0000, v13
    v_lshlrev_b32 v20, 16, v14
    v_and_b32 v21, 0xffff0000, v14
    v_lshlrev_b32 v22, 16, v15
    v_and_b32 v23, 0xffff0000, v15
    v_add_f32 v24, v16, v17
    v_add_f32 v25, v18, v19
    v_add_f32 v26, v20, v21
    v_add_f32 v27, v22, v23
    v_add_f32 v24, v24, v25
    v_add_f32 v26, v26, v27
    v_add_f32 v24, v24, v26
    s_nop 1
    v_add_f32_dpp v24, v24, v24 quad_perm:[1,0,3,2] row_mask:0xf bank_mask:0xf
    s_nop 1
    v_add_f32_dpp v24, v24, v24 quad_perm:[2,3,0,1] row_mask:0xf bank_mask:0xf
    s_nop 1
    v_add_f32_dpp v24, v24, v24 row_half_mirror row_mask:0xf bank_mask:0xf
    s_nop 1
    v_add_f32_dpp v24, v24, v24 row_mirror row_mask:0xf bank_mask:0xf
    v_mov_b32 v25, v24
    s_nop 1
    v_permlane16_swap_b32 v24, v25
    v_add_f32 v24, v24, v25
    v_mov_b32 v25, v24
    s_nop 1
    v_permlane32_swap_b32 v24, v25
    v_add_f32 v24, v24, v25
    v_mul_f32 v26, 0x3b000000, v24
    v_sub_f32 v25, v16, v26
    v_mul_f32 v24, v25, v25
    v_sub_f32 v25, v17, v26
    v_mul_f32 v27, v25, v25
    v_sub_f32 v25, v18, v26
    v_fmac_f32 v24, v25, v25
    v_sub_f32 v25, v19, v26
    v_fmac_f32 v27, v25, v25
    v_sub_f32 v25, v20, v26
    v_fmac_f32 v24, v25, v25
    v_sub_f32 v25, v21, v26
    v_fmac_f32 v27, v25, v25
    v_sub_f32 v25, v22, v26
    v_fmac_f32 v24, v25, v25
    v_sub_f32 v25, v23, v26
    v_fmac_f32 v27, v25, v25
    v_add_f32 v24, v24, v27
    s_nop 1
    v_add_f32_dpp v24, v24, v24 quad_perm:[1,0,3,2] row_mask:0xf bank_mask:0xf
    s_nop 1
    v_add_f32_dpp v24, v24, v24 quad_perm:[2,3,0,1] row_mask:0xf bank_mask:0xf
    s_nop 1
    v_add_f32_dpp v24, v24, v24 row_half_mirror row_mask:0xf bank_mask:0xf
    s_nop 1
    v_add_f32_dpp v24, v24, v24 row_mirror row_mask:0xf bank_mask:0xf
    v_mov_b32 v25, v24
    s_nop 1
    v_permlane16_swap_b32 v24, v25
    v_add_f32 v24, v24, v25
    v_mov_b32 v25, v24
    s_nop 1
    v_permlane32_swap_b32 v24, v25
    v_add_f32 v24, v24, v25
    v_mul_f32 v24, 0x3b000000, v24
    v_cvt_pk_bf16_f32 v26, v26, v26
    v_and_b32 v26, 0xffff0000, v26
    v_cvt_pk_bf16_f32 v24, v24, v24
    v_and_b32 v24, 0xffff0000, v24
    v_add_f32 v24, 0x3727c5ac, v24
    v_cvt_pk_bf16_f32 v24, v24, v24
    v_and_b32 v24, 0xffff0000, v24
    v_sqrt_f32 v24, v24
    s_nop 0
    v_cvt_pk_bf16_f32 v24, v24, v24
    v_and_b32 v24, 0xffff0000, v24
    v_rcp_f32 v24, v24
    v_sub_f32 v16, v16, v26
    v_sub_f32 v17, v17, v26
    v_sub_f32 v18, v18, v26
    v_sub_f32 v19, v19, v26
    v_sub_f32 v20, v20, v26
    v_sub_f32 v21, v21, v26
    v_sub_f32 v22, v22, v26
    v_sub_f32 v23, v23, v26
    v_cvt_pk_bf16_f32 v12, v16, v17
    v_cvt_pk_bf16_f32 v13, v18, v19
    v_cvt_pk_bf16_f32 v14, v20, v21
    v_cvt_pk_bf16_f32 v15, v22, v23
    v_lshlrev_b32 v16, 16, v12
    v_and_b32 v17, 0xffff0000, v12
    v_lshlrev_b32 v18, 16, v13
    v_and_b32 v19, 0xffff0000, v13
    v_lshlrev_b32 v20, 16, v14
    v_and_b32 v21, 0xffff0000, v14
    v_lshlrev_b32 v22, 16, v15
    v_and_b32 v23, 0xffff0000, v15
    v_mul_f32 v16, v16, v24
    v_mul_f32 v17, v17, v24
    v_mul_f32 v18, v18, v24
    v_mul_f32 v19, v19, v24
    v_mul_f32 v20, v20, v24
    v_mul_f32 v21, v21, v24
    v_mul_f32 v22, v22, v24
    v_mul_f32 v23, v23, v24
    v_cvt_pk_bf16_f32 v12, v16, v17
    v_cvt_pk_bf16_f32 v13, v18, v19
    v_cvt_pk_bf16_f32 v14, v20, v21
    v_cvt_pk_bf16_f32 v15, v22, v23
    s_cmp_eq_u32 s94, 1
    s_cbranch_scc1 L_ln_ret1
    s_cmp_eq_u32 s94, 2
    s_cbranch_scc1 L_ln_ret2
    ds_write_b128 v3, v[12:15]
    s_mov_b32 s94, 1
    s_cmp_ge_u32 s3, 2
    s_cbranch_scc1 L_ln
    s_waitcnt vmcnt(0)
    s_waitcnt lgkmcnt(0)
    s_mov_b64 exec, 1
    ds_add_u32 v5, v6 offset:0
    s_mov_b64 exec, -1
    s_add_u32 s34, s34, 0x01010101
    v_mov_b32 v29, s34
L_fw_1:
    ds_read_b32 v7, v5 offset:0
    s_waitcnt lgkmcnt(0)
    v_readfirstlane_b32 s100, v7
    s_nop 0
    s_cmp_lt_u32 s100, 4
    s_cbranch_scc1 L_fw_1
    ds_read_b64_tr_b16 v[32:33], v8 offset:0
    ds_read_b64_tr_b16 v[34:35], v8 offset:512
    ds_read_b64_tr_b16 v[36:37], v8 offset:32
    ds_read_b64_tr_b16 v[38:39], v8 offset:544
    ds_read_b128 v[40:43], v9 offset:0
    ds_read_b64_tr_b16 v[44:45], v8 offset:4096
    ds_read_b64_tr_b16 v[46:47], v8 offset:4608
    ds_read_b64_tr_b16 v[48:49], v8 offset:4128
    ds_read_b64_tr_b16 v[50:51], v8 offset:4640
    ds_read_b128 v[52:55], v9 offset:64
    ds_read_b64_tr_b16 v[56:57], v8 offset:8192
    ds_read_b64_tr_b16 v[58:59], v8 offset:8704
    ds_read_b64_tr_b16 v[60:61], v8 offset:8224
    ds_read_b64_tr_b16 v[62:63], v8 offset:8736
    ds_read_b128 v[64:67], v9 offset:128
    s_waitcnt lgkmcnt(10)
    v_mfma_f32_16x16x32_bf16 v[16:19], v[32:35], v[40:43], 0
    v_mfma_f32_16x16x32_bf16 v[20:23], v[36:39], v[40:43], 0
    ds_read_b64_tr_b16 v[68:69], v8 offset:12288
    ds_read_b64_tr_b16 v[70:71], v8 offset:12800
    ds_read_b64_tr_b16 v[72:73], v8 offset:12320
    ds_read_b64_tr_b16 v[74:75], v8 offset:12832
    ds_read_b128 v[76:79], v9 offset:192
    s_waitcnt lgkmcnt(10)
    v_mfma_f32_16x16x32_bf16 v[16:19], v[44:47], v[52:55], v[16:19]
    v_mfma_f32_16x16x32_bf16 v[20:23], v[48:51], v[52:55], v[20:23]
    s_waitcnt lgkmcnt(5)
    v_mfma_f32_16x16x32_bf16 v[16:19], v[56:59], v[64:67], v[16:19]
    v_mfma_f32_16x16x32_bf16 v[20:23], v[60:63], v[64:67], v[20:23]
    s_waitcnt lgkmcnt(0)
    v_mfma_f32_16x16x32_bf16 v[16:19], v[68:71], v[76:79], v[16:19]
    v_mfma_f32_16x16x32_bf16 v[20:23], v[72:75], v[76:79], v[20:23]
    s_nop 7
    v_cndmask_b32 v16, v16, v20, s[40:41]
    v_cndmask_b32 v17, v17, v21, s[40:41]
    v_cndmask_b32 v18, v18, v22, s[40:41]
    v_cndmask_b32 v19, v19, v23, s[40:41]
    s_mov_b32 s40, 0x00ff00ff
    s_mov_b32 s41, 0x00ff00ff
    s_mov_b64 exec, s[40:41]
    global_store_dwordx4 v10, v[16:19], s[32:33] sc1
    s_mov_b64 exec, -1
    v_xor_b32 v20, v16, v17
    v_xor_b32 v21, v18, v19
    v_xor_b32 v20, v20, v21
    s_nop 1
    v_xor_b32_dpp v20, v20, v20 row_ror:4 row_mask:0xf bank_mask:0xf
    v_mov_b32 v21, v20
    s_nop 1
    v_permlane16_swap_b32 v20, v21
    v_xor_b32 v20, v20, v21
    v_mov_b32 v21, v20
    s_nop 1
    v_permlane32_swap_b32 v20, v21
    v_xor_b32 v20, v20, v21
    v_xor_b32 v28, v20, v29
    s_mov_b64 exec, 15
    global_store_dwordx2 v11, v[28:29], s[32:33] sc1
    s_mov_b64 exec, -1
    ds_write_b32 v5, v29 offset:60
    s_mov_b32 s94, 2
    s_branch L_ln
L_ln_ret2:
    ds_write_b128 v3, v[12:15] offset:4096
    s_waitcnt lgkmcnt(0)
    s_mov_b64 exec, 1
    ds_add_u32 v5, v6 offset:4
    s_mov_b64 exec, -1
    global_load_dwordx2 v[152:153], v155, s[26:27]
    global_load_dwordx2 v[150:151], v154, s[8:9]
    s_branch L_qg
L_ln_ret1:
    ds_write_b128 v3, v[12:15] offset:4096
    s_waitcnt lgkmcnt(0)
    s_mov_b64 exec, 1
    ds_add_u32 v5, v6 offset:4
    s_mov_b64 exec, -1
    s_waitcnt vmcnt(0)
    s_mov_b64 exec, 1
    ds_add_u32 v5, v6 offset:0
    s_mov_b64 exec, -1
    s_add_u32 s34, s34, 0x01010101
    s_cmp_ge_u32 s0, 56
    s_cbranch_scc1 L_hdone
    v_mov_b32 v12, s34
    s_bfe_u32 s44, s34, 0x80000
    s_bfe_u32 s45, s34, 0x80008
    s_bfe_u32 s46, s34, 0x80010
    s_bfe_u32 s47, s34, 0x80018
    v_mov_b32 v13, 0xffffff00
    s_mov_b32 s48, 0x0c0c0400
    s_mov_b32 s49, 0x05040100
L_fw_2:
    ds_read_b32 v7, v5 offset:4
    s_waitcnt lgkmcnt(0)
    v_readfirstlane_b32 s100, v7
    s_nop 0
    s_cmp_lt_u32 s100, 4
    s_cbranch_scc1 L_fw_2
L_fw_3:
    ds_read_b32 v7, v5 offset:8
    s_waitcnt lgkmcnt(0)
    v_readfirstlane_b32 s100, v7
    s_nop 0
    s_cmp_lt_u32 s100, 8
    s_cbranch_scc1 L_fw_3
    ds_read_b64_tr_b16 v[32:33], v8 offset:0
    ds_read_b64_tr_b16 v[34:35], v8 offset:512
    ds_read_b64_tr_b16 v[36:37], v8 offset:32
    ds_read_b64_tr_b16 v[38:39], v8 offset:544
    ds_read_b128 v[40:43], v9 offset:0
    ds_read_b64_tr_b16 v[44:45], v8 offset:4096
    ds_read_b64_tr_b16 v[46:47], v8 offset:4608
    ds_read_b64_tr_b16 v[48:49], v8 offset:4128
    ds_read_b64_tr_b16 v[50:51], v8 offset:4640
    ds_read_b128 v[52:55], v9 offset:64
    s_waitcnt lgkmcnt(5)
    v_mfma_f32_16x16x32_bf16 v[16:19], v[32:35], v[40:43], 0
    v_mfma_f32_16x16x32_bf16 v[20:23], v[36:39], v[40:43], 0
    s_waitcnt lgkmcnt(0)
    v_mfma_f32_16x16x32_bf16 v[16:19], v[44:47], v[52:55], v[16:19]
    v_mfma_f32_16x16x32_bf16 v[20:23], v[48:51], v[52:55], v[20:23]
    s_nop 7
    v_cndmask_b32 v16, v16, v20, s[40:41]
    v_cndmask_b32 v17, v17, v21, s[40:41]
    v_cndmask_b32 v18, v18, v22, s[40:41]
    v_cndmask_b32 v19, v19, v23, s[40:41]
    v_and_or_b32 v16, v16, v13, s44
    v_and_or_b32 v17, v17, v13, s45
    v_and_or_b32 v18, v18, v13, s46
    v_and_or_b32 v19, v19, v13, s47
    s_mov_b32 s40, 0x00ff00ff
    s_mov_b32 s41, 0x00ff00ff
    s_mov_b64 exec, s[40:41]
    global_store_dwordx4 v10, v[16:19], s[32:33] sc1
    s_mov_b64 exec, 1
    global_store_dword v11, v12, s[32:33] sc1
    s_mov_b64 exec, -1
L_hdone:
L_qg:
    s_lshl_b32 s35, s4, 2
    s_add_u32 s35, s35, s6
    s_lshl_b32 s35, s35, 2
    s_add_u32 s35, s35, s3
    s_lshl_b32 s30, s35, 11
    s_add_u32 s30, s30, 3670016
    v_lshl_add_u32 v156, v0, 4, s30
    s_lshl_b32 s30, s35, 7
    s_add_u32 s30, s30, 3932160
    v_lshrrev_b32 v157, 3, v0
    v_lshl_add_u32 v157, v157, 3, s30
    s_add_u32 s18, s32, s30
    s_addc_u32 s19, s33, 0
    s_lshl_b32 s35, s3, 8
    s_add_u32 s35, s35, 126976
    v_and_b32 v158, 31, v0
    v_lshl_add_u32 v158, v158, 3, s35
    s_and_b32 s35, s31, 3
    v_xor_b32 v13, s35, v1
    v_xor_b32 v3, v13, v2
    s_lshl_b32 s35, s3, 14
    s_lshr_b32 s56, s31, 4
    s_lshl_b32 s56, s56, 12
    s_add_u32 s35, s35, s56
    v_lshlrev_b32 v8, 8, v13
    v_lshl_add_u32 v8, v3, 4, v8
    v_add_u32 v8, s35, v8
    v_xor_b32 v9, 64, v8
    v_xor_b32 v10, 0x80, v8
    v_xor_b32 v11, 0xc0, v8
    v_xor_b32 v144, 0x1000, v8
    v_xor_b32 v145, 0x1000, v9
    v_xor_b32 v146, 0x1000, v10
    v_xor_b32 v147, 0x1000, v11
    v_and_b32 v3, 3, v1
    v_lshlrev_b32 v12, 8, v3
    v_lshl_add_u32 v12, v2, 4, v12
    v_add_u32 v12, 126976, v12
    v_lshrrev_b32 v13, 2, v1
    v_lshlrev_b32 v14, 10, v3
    v_lshl_add_u32 v14, v13, 6, v14
    v_lshl_add_u32 v14, v2, 4, v14
    s_lshl_b32 s35, s3, 8
    s_add_u32 s35, s35, 122880
    v_add_u32 v14, s35, v14
    s_lshl_b32 s35, s3, 2
    s_add_u32 s35, s35, 128000
    v_lshl_add_u32 v15, v3, 4, s35
    s_mov_b32 s30, 0
L_qg_poll:
    s_load_dwordx16 s[36:51], s[18:19], 0 glc
    s_load_dwordx16 s[52:67], s[18:19], 64 glc
    s_waitcnt lgkmcnt(0)
    s_and_b64 s[8:9], s[36:37], s[38:39]
    s_or_b64 s[10:11], s[36:37], s[38:39]
    s_and_b64 s[8:9], s[8:9], s[40:41]
    s_or_b64 s[10:11], s[10:11], s[40:41]
    s_and_b64 s[8:9], s[8:9], s[42:43]
    s_or_b64 s[10:11], s[10:11], s[42:43]
    s_and_b64 s[8:9], s[8:9], s[44:45]
    s_or_b64 s[10:11], s[10:11], s[44:45]
    s_and_b64 s[8:9], s[8:9], s[46:47]
    s_or_b64 s[10:11], s[10:11], s[46:47]
    s_and_b64 s[8:9], s[8:9], s[48:49]
    s_or_b64 s[10:11], s[10:11], s[48:49]
    s_and_b64 s[8:9], s[8:9], s[50:51]
    s_or_b64 s[10:11], s[10:11], s[50:51]
    s_and_b64 s[8:9], s[8:9], s[52:53]
    s_or_b64 s[10:11], s[10:11], s[52:53]
    s_and_b64 s[8:9], s[8:9], s[54:55]
    s_or_b64 s[10:11], s[10:11], s[54:55]
    s_and_b64 s[8:9], s[8:9], s[56:57]
    s_or_b64 s[10:11], s[10:11], s[56:57]
    s_and_b64 s[8:9], s[8:9], s[58:59]
    s_or_b64 s[10:11], s[10:11], s[58:59]
    s_and_b64 s[8:9], s[8:9], s[60:61]
    s_or_b64 s[10:11], s[10:11], s[60:61]
    s_and_b64 s[8:9], s[8:9], s[62:63]
    s_or_b64 s[10:11], s[10:11], s[62:63]
    s_and_b64 s[8:9], s[8:9], s[64:65]
    s_or_b64 s[10:11], s[10:11], s[64:65]
    s_and_b64 s[8:9], s[8:9], s[66:67]
    s_or_b64 s[10:11], s[10:11], s[66:67]
    s_xor_b32 s9, s9, s34
    s_xor_b32 s11, s11, s34
    s_or_b32 s35, s9, s11
    s_add_u32 s30, s30, 1
    s_cmp_ge_u32 s30, 0x80000
    s_cbranch_scc1 L_qg_data
    s_cmp_lg_u32 s35, 0
    s_cbranch_scc1 L_qg_poll
L_qg_data:
    global_load_dwordx4 v[32:35], v156, s[32:33] sc1
    global_load_dwordx4 v[36:39], v156, s[32:33] offset:1024 sc1
    global_load_dword v40, v157, s[32:33] sc1
    global_load_dword v41, v157, s[32:33] offset:64 sc1
    s_mov_b32 s38, 0xf000f0
    s_mov_b32 s39, 0xf000f0
    s_mov_b32 s40, 0xf000f00
    s_mov_b32 s41, 0xf000f00
    s_mov_b32 s42, 0xf000f000
    s_mov_b32 s43, 0xf000f000
L_fw_4:
    ds_read_b32 v7, v5 offset:16
    s_waitcnt lgkmcnt(0)
    v_readfirstlane_b32 s100, v7
    s_nop 0
    s_cmp_lt_u32 s100, 8
    s_cbranch_scc1 L_fw_4
    ds_read_b128 v[64:67], v8 offset:0
    ds_read_b128 v[68:71], v9 offset:0
    ds_read_b128 v[72:75], v10 offset:0
    ds_read_b128 v[76:79], v11 offset:0
    ds_read_b128 v[80:83], v144 offset:0
    ds_read_b128 v[84:87], v145 offset:0
    ds_read_b128 v[88:91], v146 offset:0
    ds_read_b128 v[92:95], v147 offset:0
    ds_read_b128 v[96:99], v8 offset:8192
    ds_read_b128 v[100:103], v9 offset:8192
    ds_read_b128 v[104:107], v10 offset:8192
    ds_read_b128 v[108:111], v11 offset:8192
    ds_read_b128 v[112:115], v144 offset:8192
    ds_read_b128 v[116:119], v145 offset:8192
    ds_read_b128 v[120:123], v146 offset:8192
    ds_read_b128 v[124:127], v147 offset:8192
    s_branch L_qg_wait
L_qg_retry:
    global_load_dwordx4 v[32:35], v156, s[32:33] sc1
    global_load_dwordx4 v[36:39], v156, s[32:33] offset:1024 sc1
    global_load_dword v40, v157, s[32:33] sc1
    global_load_dword v41, v157, s[32:33] offset:64 sc1
L_qg_wait:
    s_waitcnt vmcnt(0)
    v_xor_b32 v42, v32, v33
    v_xor_b32 v44, v34, v35
    v_xor_b32 v43, v36, v37
    v_xor_b32 v45, v38, v39
    v_xor_b32 v42, v42, v44
    v_xor_b32 v43, v43, v45
    s_nop 0
    v_xor_b32_dpp v42, v42, v42 quad_perm:[1,0,3,2] row_mask:0xf bank_mask:0xf
    v_xor_b32_dpp v43, v43, v43 quad_perm:[1,0,3,2] row_mask:0xf bank_mask:0xf
    s_nop 0
    v_xor_b32_dpp v42, v42, v42 quad_perm:[2,3,0,1] row_mask:0xf bank_mask:0xf
    v_xor_b32_dpp v43, v43, v43 quad_perm:[2,3,0,1] row_mask:0xf bank_mask:0xf
    s_nop 0
    v_xor_b32_dpp v42, v42, v42 row_half_mirror row_mask:0xf bank_mask:0xf
    v_xor_b32_dpp v43, v43, v43 row_half_mirror row_mask:0xf bank_mask:0xf
    v_xor_b32 v42, v42, v40
    v_xor_b32 v43, v43, v41
    v_cmp_ne_u32 vcc, s34, v42
    v_cmp_ne_u32 s[54:55], s34, v43
    s_nop 0
    s_or_b64 s[54:55], s[54:55], vcc
    s_add_u32 s30, s30, 1
    s_cmp_ge_u32 s30, 0x90000
    s_cbranch_scc1 L_qg_done
    s_cmp_lg_u64 s[54:55], 0
    s_cbranch_scc1 L_qg_retry
L_qg_done:
L_dry_qk:
    v_add_f32 v32, v32, v36
    v_add_f32 v33, v33, v37
    v_add_f32 v34, v34, v38
    v_add_f32 v35, v35, v39
    v_mov_b32 v36, v32
    v_mov_b32 v37, v33
    v_mov_b32 v38, v34
    v_mov_b32 v39, v35
    v_permlane32_swap_b32 v32, v36
    v_permlane32_swap_b32 v33, v37
    v_permlane32_swap_b32 v34, v38
    v_permlane32_swap_b32 v35, v39
    v_add_f32 v32, v32, v36
    v_add_f32 v33, v33, v37
    v_add_f32 v34, v34, v38
    v_add_f32 v35, v35, v39
    v_cvt_pk_bf16_f32 v16, v32, v33
    v_cvt_pk_bf16_f32 v17, v34, v35
    ds_write_b64 v158, v[16:17]
    s_waitcnt lgkmcnt(0)
    s_mov_b64 exec, 1
    ds_add_u32 v5, v6 offset:12
    s_mov_b64 exec, -1
L_fw_5:
    ds_read_b32 v7, v5 offset:12
    s_waitcnt lgkmcnt(0)
    v_readfirstlane_b32 s100, v7
    s_nop 0
    s_cmp_lt_u32 s100, 4
    s_cbranch_scc1 L_fw_5
    ds_read_b128 v[32:35], v12 offset:0
    ds_read_b128 v[36:39], v12 offset:64
    ds_read_b128 v[40:43], v12 offset:128
    ds_read_b128 v[44:47], v12 offset:192
    s_waitcnt lgkmcnt(3)
    v_mfma_f32_16x16x32_bf16 v[16:19], v[64:67], v[32:35], 0
    v_mfma_f32_16x16x32_bf16 v[20:23], v[80:83], v[32:35], 0
    v_mfma_f32_16x16x32_bf16 v[24:27], v[96:99], v[32:35], 0
    v_mfma_f32_16x16x32_bf16 v[28:31], v[112:115], v[32:35], 0
    s_waitcnt lgkmcnt(2)
    v_mfma_f32_16x16x32_bf16 v[16:19], v[68:71], v[36:39], v[16:19]
    v_mfma_f32_16x16x32_bf16 v[20:23], v[84:87], v[36:39], v[20:23]
    v_mfma_f32_16x16x32_bf16 v[24:27], v[100:103], v[36:39], v[24:27]
    v_mfma_f32_16x16x32_bf16 v[28:31], v[116:119], v[36:39], v[28:31]
    s_waitcnt lgkmcnt(1)
    v_mfma_f32_16x16x32_bf16 v[16:19], v[72:75], v[40:43], v[16:19]
    v_mfma_f32_16x16x32_bf16 v[20:23], v[88:91], v[40:43], v[20:23]
    v_mfma_f32_16x16x32_bf16 v[24:27], v[104:107], v[40:43], v[24:27]
    v_mfma_f32_16x16x32_bf16 v[28:31], v[120:123], v[40:43], v[28:31]
    s_waitcnt lgkmcnt(0)
    v_mfma_f32_16x16x32_bf16 v[16:19], v[76:79], v[44:47], v[16:19]
    v_mfma_f32_16x16x32_bf16 v[20:23], v[92:95], v[44:47], v[20:23]
    v_mfma_f32_16x16x32_bf16 v[24:27], v[108:111], v[44:47], v[24:27]
    v_mfma_f32_16x16x32_bf16 v[28:31], v[124:127], v[44:47], v[28:31]
    s_mov_b32 s35, 0x3db504f3
    s_mov_b32 s18, 0x3fb8aa3b
    s_nop 3
    v_cndmask_b32 v16, v16, v20, s[38:39]
    v_cndmask_b32 v17, v17, v21, s[38:39]
    v_cndmask_b32 v18, v18, v22, s[38:39]
    v_cndmask_b32 v19, v19, v23, s[38:39]
    v_cndmask_b32 v16, v16, v24, s[40:41]
    v_cndmask_b32 v17, v17, v25, s[40:41]
    v_cndmask_b32 v18, v18, v26, s[40:41]
    v_cndmask_b32 v19, v19, v27, s[40:41]
    v_cndmask_b32 v16, v16, v28, s[42:43]
    v_cndmask_b32 v17, v17, v29, s[42:43]
    v_cndmask_b32 v18, v18, v30, s[42:43]
    v_cndmask_b32 v19, v19, v31, s[42:43]
    v_cvt_pk_bf16_f32 v20, v16, v17
    v_cvt_pk_bf16_f32 v21, v18, v19
    v_lshlrev_b32 v16, 16, v20
    v_and_b32 v17, 0xffff0000, v20
    v_lshlrev_b32 v18, 16, v21
    v_and_b32 v19, 0xffff0000, v21
    v_mul_f32 v16, s35, v16
    v_mul_f32 v17, s35, v17
    v_mul_f32 v18, s35, v18
    v_mul_f32 v19, s35, v19
    v_cvt_pk_bf16_f32 v20, v16, v17
    v_cvt_pk_bf16_f32 v21, v18, v19
    v_lshlrev_b32 v16, 16, v20
    v_and_b32 v17, 0xffff0000, v20
    v_lshlrev_b32 v18, 16, v21
    v_and_b32 v19, 0xffff0000, v21
    v_max3_f32 v20, v16, v17, v18
    v_max_f32 v20, v20, v19
    s_nop 1
    v_max_f32_dpp v20, v20, v20 row_ror:4 row_mask:0xf bank_mask:0xf
    s_nop 1
    v_max_f32_dpp v20, v20, v20 row_ror:8 row_mask:0xf bank_mask:0xf
    v_mov_b32 v21, v20
    s_nop 1
    v_permlane16_swap_b32 v20, v21
    v_max_f32 v20, v20, v21
    v_mov_b32 v21, v20
    s_nop 1
    v_permlane32_swap_b32 v20, v21
    v_max_f32 v20, v20, v21
    v_sub_f32 v16, v16, v20
    v_sub_f32 v17, v17, v20
    v_sub_f32 v18, v18, v20
    v_sub_f32 v19, v19, v20
    v_mul_f32 v16, s18, v16
    v_mul_f32 v17, s18, v17
    v_mul_f32 v18, s18, v18
    v_mul_f32 v19, s18, v19
    v_exp_f32 v16, v16
    v_exp_f32 v17, v17
    v_exp_f32 v18, v18
    v_exp_f32 v19, v19
    v_cvt_pk_bf16_f32 v24, v16, v16
    v_cvt_pk_bf16_f32 v25, v17, v17
    v_cvt_pk_bf16_f32 v26, v18, v18
    v_cvt_pk_bf16_f32 v27, v19, v19
    ds_write_b128 v14, v[24:27]
    ds_write_b32 v15, v20
    v_add_f32 v22, v16, v17
    v_add_f32 v23, v18, v19
    v_add_f32 v22, v22, v23
    s_nop 1
    v_add_f32_dpp v22, v22, v22 row_ror:4 row_mask:0xf bank_mask:0xf
    s_nop 1
    v_add_f32_dpp v22, v22, v22 row_ror:8 row_mask:0xf bank_mask:0xf
    v_mov_b32 v21, v22
    s_nop 1
    v_permlane16_swap_b32 v22, v21
    v_add_f32 v22, v22, v21
    v_mov_b32 v21, v22
    s_nop 1
    v_permlane32_swap_b32 v22, v21
    v_add_f32 v22, v22, v21
    ds_write_b32 v15, v22 offset:64
    s_waitcnt lgkmcnt(0)
    s_mov_b64 exec, 1
    ds_add_u32 v5, v6 offset:20
    s_mov_b64 exec, -1
    s_bfe_u32 s44, s34, 0x80000
    s_bfe_u32 s45, s34, 0x80008
    s_bfe_u32 s46, s34, 0x80010
    s_bfe_u32 s47, s34, 0x80018
    v_mov_b32 v31, 0xffffff00
    s_mov_b32 s48, 0x0c0c0400
    s_mov_b32 s49, 0x05040100
    s_cmp_ge_u32 s0, 56
    s_cbranch_scc1 L_otail
    s_cmp_lg_u32 s3, 1
    s_cbranch_scc1 L_otail
    s_lshl_b32 s35, s0, 6
    v_and_b32 v8, 7, v0
    v_lshl_add_u32 v8, v8, 3, s35
    global_load_dwordx2 v[28:29], v8, s[22:23]
    s_lshl_b32 s35, s0, 12
    s_add_u32 s35, s35, 262144
    v_lshl_add_u32 v8, v0, 4, s35
    s_lshl_b32 s35, s0, 6
    s_add_u32 s35, s35, 524288
    s_add_u32 s18, s32, s35
    s_addc_u32 s19, s33, 0
    s_mov_b32 s30, 0
L_hfpoll:
    s_load_dwordx8 s[64:71], s[18:19], 0 glc
    s_waitcnt lgkmcnt(0)
    s_xor_b32 s35, s64, s34
    s_xor_b32 s100, s65, s34
    s_or_b32 s35, s35, s100
    s_xor_b32 s100, s66, s34
    s_or_b32 s35, s35, s100
    s_xor_b32 s100, s67, s34
    s_or_b32 s35, s35, s100
    s_xor_b32 s100, s68, s34
    s_or_b32 s35, s35, s100
    s_xor_b32 s100, s69, s34
    s_or_b32 s35, s35, s100
    s_xor_b32 s100, s70, s34
    s_or_b32 s35, s35, s100
    s_xor_b32 s100, s71, s34
    s_or_b32 s35, s35, s100
    s_add_u32 s30, s30, 1
    s_cmp_ge_u32 s30, 0x80000
    s_cbranch_scc1 L_hfdone
    s_cmp_eq_u32 s35, 0
    s_cbranch_scc1 L_hfdone
    s_sleep 4
    s_branch L_hfpoll
L_hfdone:
    s_mov_b64 s[62:63], -1
    s_mov_b64 s[64:65], -1
    s_mov_b64 s[66:67], -1
    s_mov_b64 s[68:69], -1
    s_mov_b32 s59, 0
L_g_6:
    s_mov_b64 exec, s[62:63]
    s_cbranch_execz L_gs_8
    global_load_dwordx4 v[32:35], v8, s[32:33] offset:0 sc1
L_gs_8:
    s_mov_b64 exec, s[64:65]
    s_cbranch_execz L_gs_9
    global_load_dwordx4 v[36:39], v8, s[32:33] offset:1024 sc1
L_gs_9:
    s_mov_b64 exec, s[66:67]
    s_cbranch_execz L_gs_10
    global_load_dwordx4 v[40:43], v8, s[32:33] offset:2048 sc1
L_gs_10:
    s_mov_b64 exec, s[68:69]
    s_cbranch_execz L_gs_11
    global_load_dwordx4 v[44:47], v8, s[32:33] offset:3072 sc1
L_gs_11:
    s_mov_b64 exec, -1
    s_waitcnt vmcnt(0)
    s_mov_b64 s[56:57], 0
    v_perm_b32 v60, v33, v32, s48
    v_perm_b32 v61, v35, v34, s48
    v_perm_b32 v60, v61, v60, s49
    v_cmp_ne_u32 s[54:55], s34, v60
    s_nop 0
    s_and_b64 s[62:63], s[62:63], s[54:55]
    s_or_b64 s[56:57], s[56:57], s[62:63]
    v_perm_b32 v60, v37, v36, s48
    v_perm_b32 v61, v39, v38, s48
    v_perm_b32 v60, v61, v60, s49
    v_cmp_ne_u32 s[54:55], s34, v60
    s_nop 0
    s_and_b64 s[64:65], s[64:65], s[54:55]
    s_or_b64 s[56:57], s[56:57], s[64:65]
    v_perm_b32 v60, v41, v40, s48
    v_perm_b32 v61, v43, v42, s48
    v_perm_b32 v60, v61, v60, s49
    v_cmp_ne_u32 s[54:55], s34, v60
    s_nop 0
    s_and_b64 s[66:67], s[66:67], s[54:55]
    s_or_b64 s[56:57], s[56:57], s[66:67]
    v_perm_b32 v60, v45, v44, s48
    v_perm_b32 v61, v47, v46, s48
    v_perm_b32 v60, v61, v60, s49
    v_cmp_ne_u32 s[54:55], s34, v60
    s_nop 0
    s_and_b64 s[68:69], s[68:69], s[54:55]
    s_or_b64 s[56:57], s[56:57], s[68:69]
    s_add_u32 s59, s59, 1
    s_cmp_ge_u32 s59, 0x40000
    s_cbranch_scc1 L_gd_7
    s_cmp_lg_u64 s[56:57], 0
    s_cbranch_scc1 L_g_6
L_gd_7:
    v_and_b32 v32, 0xffffff00, v32
    v_and_b32 v33, 0xffffff00, v33
    v_and_b32 v34, 0xffffff00, v34
    v_and_b32 v35, 0xffffff00, v35
    v_and_b32 v36, 0xffffff00, v36
    v_and_b32 v37, 0xffffff00, v37
    v_and_b32 v38, 0xffffff00, v38
    v_and_b32 v39, 0xffffff00, v39
    v_and_b32 v40, 0xffffff00, v40
    v_and_b32 v41, 0xffffff00, v41
    v_and_b32 v42, 0xffffff00, v42
    v_and_b32 v43, 0xffffff00, v43
    v_and_b32 v44, 0xffffff00, v44
    v_and_b32 v45, 0xffffff00, v45
    v_and_b32 v46, 0xffffff00, v46
    v_and_b32 v47, 0xffffff00, v47
    v_add_f32 v32, v32, v36
    v_add_f32 v40, v40, v44
    v_add_f32 v33, v33, v37
    v_add_f32 v41, v41, v45
    v_add_f32 v34, v34, v38
    v_add_f32 v42, v42, v46
    v_add_f32 v35, v35, v39
    v_add_f32 v43, v43, v47
    v_add_f32 v32, v32, v40
    v_add_f32 v33, v33, v41
    v_add_f32 v34, v34, v42
    v_add_f32 v35, v35, v43
    v_mov_b32 v36, v32
    v_mov_b32 v37, v33
    v_mov_b32 v38, v34
    v_mov_b32 v39, v35
    v_permlane32_swap_b32 v32, v36
    v_permlane32_swap_b32 v33, v37
    v_permlane32_swap_b32 v34, v38
    v_permlane32_swap_b32 v35, v39
    v_add_f32 v32, v32, v36
    v_add_f32 v33, v33, v37
    v_add_f32 v34, v34, v38
    v_add_f32 v35, v35, v39
    v_cvt_pk_bf16_f32 v36, v32, v33
    v_cvt_pk_bf16_f32 v37, v34, v35
    v_lshlrev_b32 v32, 16, v36
    v_and_b32 v33, 0xffff0000, v36
    v_lshlrev_b32 v34, 16, v37
    v_and_b32 v35, 0xffff0000, v37
    v_lshlrev_b32 v36, 16, v28
    v_and_b32 v37, 0xffff0000, v28
    v_lshlrev_b32 v38, 16, v29
    v_and_b32 v39, 0xffff0000, v29
    v_add_f32 v32, v32, v36
    v_add_f32 v33, v33, v37
    v_add_f32 v34, v34, v38
    v_add_f32 v35, v35, v39
    v_cvt_pk_bf16_f32 v36, v32, v33
    v_cvt_pk_bf16_f32 v37, v34, v35
    v_lshlrev_b32 v32, 16, v36
    v_and_b32 v33, 0xffff0000, v36
    v_lshlrev_b32 v34, 16, v37
    v_and_b32 v35, 0xffff0000, v37
    s_mov_b32 s35, 0xbdd2d3e8
    v_mov_b32 v40, 0xc0135761
    v_mul_f32 v36, v32, v32
    v_mul_f32 v37, v33, v33
    v_mul_f32 v38, v34, v34
    v_mul_f32 v39, v35, v35
    v_fma_f32 v36, v36, s35, v40
    v_fma_f32 v37, v37, s35, v40
    v_fma_f32 v38, v38, s35, v40
    v_fma_f32 v39, v39, s35, v40
    v_mul_f32 v36, v36, v32
    v_mul_f32 v37, v37, v33
    v_mul_f32 v38, v38, v34
    v_mul_f32 v39, v39, v35
    v_exp_f32 v36, v36
    v_exp_f32 v37, v37
    v_exp_f32 v38, v38
    v_exp_f32 v39, v39
    v_add_f32 v36, 1.0, v36
    v_add_f32 v37, 1.0, v37
    v_add_f32 v38, 1.0, v38
    v_add_f32 v39, 1.0, v39
    v_rcp_f32 v36, v36
    v_rcp_f32 v37, v37
    v_rcp_f32 v38, v38
    v_rcp_f32 v39, v39
    v_mul_f32 v32, v32, v36
    v_mul_f32 v33, v33, v37
    v_mul_f32 v34, v34, v38
    v_mul_f32 v35, v35, v39
    v_cvt_pk_bf16_f32 v32, v32, v32
    v_cvt_pk_bf16_f32 v33, v33, v33
    v_cvt_pk_bf16_f32 v34, v34, v34
    v_cvt_pk_bf16_f32 v35, v35, v35
    v_bfe_u32 v8, v0, 3, 2
    v_lshlrev_b32 v8, 7, v8
    v_and_b32 v9, 1, v0
    v_lshl_add_u32 v8, v9, 6, v8
    v_bfe_u32 v9, v0, 1, 2
    v_lshl_add_u32 v8, v9, 2, v8
    v_add_u32 v8, 129152, v8
    ds_write2_b32 v8, v32, v33 offset0:0 offset1:4
    ds_write2_b32 v8, v34, v35 offset0:8 offset1:12
    s_waitcnt lgkmcnt(0)
    s_mov_b64 exec, 1
    ds_add_u32 v5, v6 offset:28
    s_mov_b64 exec, -1
L_otail:
    s_lshl_b32 s35, s3, 3
    s_add_u32 s35, s35, s4
    s_lshl_b32 s35, s35, 3
    s_add_u32 s35, s35, s5
    s_lshl_b32 s18, s35, 11
    s_add_u32 s18, s18, 1048576
    v_lshl_add_u32 v10, v0, 4, s18
    s_lshl_b32 s18, s35, 7
    s_add_u32 s18, s18, 1572864
    v_lshl_add_u32 v11, v2, 4, s18
    v_and_b32 v16, 7, v0
    v_lshl_add_u32 v16, v16, 4, s18
    v_and_b32 v12, 1, v1
    v_lshlrev_b32 v12, 7, v12
    v_lshrrev_b32 v13, 1, v1
    v_lshl_add_u32 v12, v13, 2, v12
    s_lshl_b32 s35, s3, 8
    s_add_u32 s35, s35, 128128
    v_add_u32 v12, s35, v12
    v_and_b32 v3, 1, v0
    v_lshlrev_b32 v15, 4, v3
    v_add_u32 v15, 129664, v15
    s_lshl_b32 s35, s3, 2
    v_add_u32 v9, s35, v5
L_fw_12:
    ds_read_b32 v7, v5 offset:40
    s_waitcnt lgkmcnt(0)
    v_readfirstlane_b32 s100, v7
    s_nop 0
    s_cmp_lt_u32 s100, 8
    s_cbranch_scc1 L_fw_12
    v_readfirstlane_b32 s35, v11
    s_nop 0
    s_add_u32 s18, s32, s35
    s_addc_u32 s19, s33, 0
    s_mov_b32 s59, 0
L_of_13:
    s_load_dwordx16 s[64:79], s[18:19], 0 glc
    s_load_dwordx16 s[80:95], s[18:19], 64 glc
    s_waitcnt lgkmcnt(0)
    s_mov_b32 s58, 0
    s_cmp_eq_u32 s65, s34
    s_addc_u32 s58, s58, 0
    s_cmp_eq_u32 s69, s34
    s_addc_u32 s58, s58, 0
    s_cmp_eq_u32 s73, s34
    s_addc_u32 s58, s58, 0
    s_cmp_eq_u32 s77, s34
    s_addc_u32 s58, s58, 0
    s_cmp_eq_u32 s81, s34
    s_addc_u32 s58, s58, 0
    s_cmp_eq_u32 s85, s34
    s_addc_u32 s58, s58, 0
    s_cmp_eq_u32 s89, s34
    s_addc_u32 s58, s58, 0
    s_cmp_eq_u32 s93, s34
    s_addc_u32 s58, s58, 0
    s_add_u32 s59, s59, 1
    s_cmp_ge_u32 s59, 0x80000
    s_cbranch_scc1 L_ofd_14
    s_cmp_lt_u32 s58, 8
    s_cbranch_scc0 L_ofd_14
    s_sleep 1
    s_branch L_of_13
L_ofd_14:
    s_mov_b64 s[62:63], -1
    s_mov_b64 s[64:65], -1
    s_mov_b64 s[66:67], -1
    s_mov_b64 s[68:69], -1
    s_mov_b32 s59, 0
L_g_15:
    s_mov_b64 exec, s[62:63]
    s_cbranch_execz L_gs_17
    global_load_dwordx4 v[32:35], v10, s[32:33] offset:0 sc1
L_gs_17:
    s_mov_b64 exec, s[64:65]
    s_cbranch_execz L_gs_18
    global_load_dwordx4 v[36:39], v10, s[32:33] offset:1024 sc1
L_gs_18:
    s_mov_b64 exec, s[66:67]
    s_cbranch_execz L_gs_19
    global_load_dwordx4 v[40:43], v11, s[32:33] offset:0 sc1
L_gs_19:
    s_mov_b64 exec, s[68:69]
    s_cbranch_execz L_gs_20
    global_load_dwordx4 v[44:47], v11, s[32:33] offset:64 sc1
L_gs_20:
    s_mov_b64 exec, -1
    s_waitcnt vmcnt(0)
    s_mov_b64 s[56:57], 0
    v_perm_b32 v60, v33, v32, s48
    v_perm_b32 v61, v35, v34, s48
    v_perm_b32 v60, v61, v60, s49
    v_cmp_ne_u32 s[54:55], s34, v60
    s_nop 0
    s_and_b64 s[62:63], s[62:63], s[54:55]
    s_or_b64 s[56:57], s[56:57], s[62:63]
    v_perm_b32 v60, v37, v36, s48
    v_perm_b32 v61, v39, v38, s48
    v_perm_b32 v60, v61, v60, s49
    v_cmp_ne_u32 s[54:55], s34, v60
    s_nop 0
    s_and_b64 s[64:65], s[64:65], s[54:55]
    s_or_b64 s[56:57], s[56:57], s[64:65]
    v_cmp_ne_u32 vcc, s34, v41
    v_cmp_ne_u32 s[54:55], s34, v43
    s_nop 0
    s_or_b64 s[54:55], s[54:55], vcc
    s_and_b64 s[66:67], s[66:67], s[54:55]
    s_or_b64 s[56:57], s[56:57], s[66:67]
    v_cmp_ne_u32 vcc, s34, v45
    v_cmp_ne_u32 s[54:55], s34, v47
    s_nop 0
    s_or_b64 s[54:55], s[54:55], vcc
    s_and_b64 s[68:69], s[68:69], s[54:55]
    s_or_b64 s[56:57], s[56:57], s[68:69]
    s_add_u32 s59, s59, 1
    s_cmp_ge_u32 s59, 0x40000
    s_cbranch_scc1 L_gd_16
    s_cmp_lg_u64 s[56:57], 0
    s_cbranch_scc1 L_g_15
L_gd_16:
    v_and_b32 v32, 0xffffff00, v32
    v_and_b32 v33, 0xffffff00, v33
    v_and_b32 v34, 0xffffff00, v34
    v_and_b32 v35, 0xffffff00, v35
    v_and_b32 v36, 0xffffff00, v36
    v_and_b32 v37, 0xffffff00, v37
    v_and_b32 v38, 0xffffff00, v38
    v_and_b32 v39, 0xffffff00, v39
    v_max_f32 v16, v40, v44
    v_mov_b32 v17, v16
    s_nop 1
    v_permlane16_swap_b32 v16, v17
    v_max_f32 v16, v16, v17
    v_mov_b32 v17, v16
    s_nop 1
    v_permlane32_swap_b32 v16, v17
    v_max_f32 v16, v16, v17
    v_sub_f32 v40, v40, v16
    v_sub_f32 v44, v44, v16
    v_mul_f32 v40, 1069066811, v40
    v_mul_f32 v44, 1069066811, v44
    v_exp_f32 v40, v40
    v_exp_f32 v44, v44
    v_mul_f32 v20, v40, v42
    v_mul_f32 v16, v40, v32
    v_mul_f32 v17, v40, v33
    v_mul_f32 v18, v40, v34
    v_mul_f32 v19, v40, v35
    v_fmac_f32 v20, v44, v46
    v_fmac_f32 v16, v44, v36
    v_fmac_f32 v17, v44, v37
    v_fmac_f32 v18, v44, v38
    v_fmac_f32 v19, v44, v39
    v_mov_b32 v32, v16
    v_mov_b32 v33, v17
    v_mov_b32 v34, v18
    v_mov_b32 v35, v19
    v_mov_b32 v36, v20
    v_permlane16_swap_b32 v16, v32
    v_permlane16_swap_b32 v17, v33
    v_permlane16_swap_b32 v18, v34
    v_permlane16_swap_b32 v19, v35
    v_permlane16_swap_b32 v20, v36
    v_add_f32 v16, v16, v32
    v_add_f32 v17, v17, v33
    v_add_f32 v18, v18, v34
    v_add_f32 v19, v19, v35
    v_add_f32 v20, v20, v36
    v_mov_b32 v32, v16
    v_mov_b32 v33, v17
    v_mov_b32 v34, v18
    v_mov_b32 v35, v19
    v_mov_b32 v36, v20
    v_permlane32_swap_b32 v16, v32
    v_permlane32_swap_b32 v17, v33
    v_permlane32_swap_b32 v18, v34
    v_permlane32_swap_b32 v19, v35
    v_permlane32_swap_b32 v20, v36
    v_add_f32 v16, v16, v32
    v_add_f32 v17, v17, v33
    v_add_f32 v18, v18, v34
    v_add_f32 v19, v19, v35
    v_add_f32 v20, v20, v36
    v_rcp_f32 v20, v20
    s_nop 0
    v_mul_f32 v16, v16, v20
    v_mul_f32 v17, v17, v20
    v_mul_f32 v18, v18, v20
    v_mul_f32 v19, v19, v20
    v_cvt_pk_bf16_f32 v16, v16, v16
    v_cvt_pk_bf16_f32 v17, v17, v17
    v_cvt_pk_bf16_f32 v18, v18, v18
    v_cvt_pk_bf16_f32 v19, v19, v19
    ds_write2_b32 v12, v16, v17 offset0:0 offset1:8
    ds_write2_b32 v12, v18, v19 offset0:16 offset1:24
    s_waitcnt lgkmcnt(0)
    s_mov_b64 exec, 1
    ds_add_u32 v9, v6 offset:64
    s_mov_b64 exec, -1
    s_lshr_b32 s19, s7, 2
    s_xor_b32 s35, s19, s7
    s_and_b32 s35, s35, 3
    s_cmp_lg_u32 s35, 0
    s_cbranch_scc1 L_dbg_exit
    s_lshl_b32 s35, s6, 4
    s_add_u32 s35, s35, s19
    s_lshl_b32 s35, s35, 13
    s_lshl_b32 s30, s3, 11
    s_add_u32 s35, s35, s30
    s_add_u32 s35, s35, 2097152
    v_lshl_add_u32 v14, v0, 4, s35
    v_add_u32 v13, 524288, v14
    v_and_b32 v3, 7, v0
    v_lshlrev_b32 v15, 4, v3
    s_lshl_b32 s35, s3, 7
    s_add_u32 s35, s35, 129792
    v_add_u32 v12, s35, v15
    v_add_u32 v15, 129664, v15
    v_mov_b32 v36, 0
    v_mov_b32 v37, 0
    v_mov_b32 v38, 0
    v_mov_b32 v39, 0
    s_cmp_lt_u32 s3, 3
    s_cselect_b64 s[40:41], -1, 0
    s_mov_b64 s[62:63], -1
    s_mov_b64 s[64:65], s[40:41]
    s_mov_b32 s59, 0
L_g_21:
    s_mov_b64 exec, s[62:63]
    s_cbranch_execz L_gs_23
    global_load_dwordx4 v[32:35], v13, s[32:33] offset:0 sc1
L_gs_23:
    s_mov_b64 exec, s[64:65]
    s_cbranch_execz L_gs_24
    global_load_dwordx4 v[36:39], v13, s[32:33] offset:1024 sc1
L_gs_24:
    s_mov_b64 exec, -1
    s_waitcnt vmcnt(0)
    s_mov_b64 s[56:57], 0
    v_perm_b32 v60, v33, v32, s48
    v_perm_b32 v61, v35, v34, s48
    v_perm_b32 v60, v61, v60, s49
    v_cmp_ne_u32 s[54:55], s34, v60
    s_nop 0
    s_and_b64 s[62:63], s[62:63], s[54:55]
    s_or_b64 s[56:57], s[56:57], s[62:63]
    v_perm_b32 v60, v37, v36, s48
    v_perm_b32 v61, v39, v38, s48
    v_perm_b32 v60, v61, v60, s49
    v_cmp_ne_u32 s[54:55], s34, v60
    s_nop 0
    s_and_b64 s[64:65], s[64:65], s[54:55]
    s_or_b64 s[56:57], s[56:57], s[64:65]
    s_add_u32 s59, s59, 1
    s_cmp_ge_u32 s59, 0x40000
    s_cbranch_scc1 L_gd_22
    s_cmp_lg_u64 s[56:57], 0
    s_cbranch_scc1 L_g_21
L_gd_22:
    v_and_b32 v32, 0xffffff00, v32
    v_and_b32 v33, 0xffffff00, v33
    v_and_b32 v34, 0xffffff00, v34
    v_and_b32 v35, 0xffffff00, v35
    v_and_b32 v36, 0xffffff00, v36
    v_and_b32 v37, 0xffffff00, v37
    v_and_b32 v38, 0xffffff00, v38
    v_and_b32 v39, 0xffffff00, v39
    v_add_f32 v32, v32, v36
    v_add_f32 v33, v33, v37
    v_add_f32 v34, v34, v38
    v_add_f32 v35, v35, v39
    v_add_f32_dpp v32, v32, v32 row_ror:8 row_mask:0xf bank_mask:0xf
    v_add_f32_dpp v33, v33, v33 row_ror:8 row_mask:0xf bank_mask:0xf
    v_add_f32_dpp v34, v34, v34 row_ror:8 row_mask:0xf bank_mask:0xf
    v_add_f32_dpp v35, v35, v35 row_ror:8 row_mask:0xf bank_mask:0xf
    v_mov_b32 v36, v32
    v_mov_b32 v37, v33
    v_mov_b32 v38, v34
    v_mov_b32 v39, v35
    v_permlane16_swap_b32 v32, v36
    v_permlane16_swap_b32 v33, v37
    v_permlane16_swap_b32 v34, v38
    v_permlane16_swap_b32 v35, v39
    v_add_f32 v32, v32, v36
    v_add_f32 v33, v33, v37
    v_add_f32 v34, v34, v38
    v_add_f32 v35, v35, v39
    v_mov_b32 v36, v32
    v_mov_b32 v37, v33
    v_mov_b32 v38, v34
    v_mov_b32 v39, v35
    v_permlane32_swap_b32 v32, v36
    v_permlane32_swap_b32 v33, v37
    v_permlane32_swap_b32 v34, v38
    v_permlane32_swap_b32 v35, v39
    v_add_f32 v32, v32, v36
    v_add_f32 v33, v33, v37
    v_add_f32 v34, v34, v38
    v_add_f32 v35, v35, v39
    ds_write_b128 v12, v[32:35]
    s_waitcnt lgkmcnt(0)
    s_mov_b64 exec, 1
    ds_add_u32 v5, v6 offset:24
    s_mov_b64 exec, -1
    s_cmp_lg_u32 s3, 1
    s_cbranch_scc1 L_fg
L_fw_25:
    ds_read_b32 v7, v5 offset:24
    s_waitcnt lgkmcnt(0)
    v_readfirstlane_b32 s100, v7
    s_nop 0
    s_cmp_lt_u32 s100, 4
    s_cbranch_scc1 L_fw_25
    ds_read_b128 v[32:35], v15 offset:128
    ds_read_b128 v[36:39], v15 offset:256
    ds_read_b128 v[40:43], v15 offset:384
    ds_read_b128 v[44:47], v15 offset:512
    s_waitcnt lgkmcnt(0)
    v_add_f32 v32, v32, v36
    v_add_f32 v40, v40, v44
    v_add_f32 v33, v33, v37
    v_add_f32 v41, v41, v45
    v_add_f32 v34, v34, v38
    v_add_f32 v42, v42, v46
    v_add_f32 v35, v35, v39
    v_add_f32 v43, v43, v47
    v_add_f32 v32, v32, v40
    v_add_f32 v33, v33, v41
    v_add_f32 v34, v34, v42
    v_add_f32 v35, v35, v43
    v_cvt_pk_bf16_f32 v36, v32, v33
    v_cvt_pk_bf16_f32 v37, v34, v35
    v_lshlrev_b32 v32, 16, v36
    v_and_b32 v33, 0xffff0000, v36
    v_lshlrev_b32 v34, 16, v37
    v_and_b32 v35, 0xffff0000, v37
    v_lshlrev_b32 v36, 16, v152
    v_and_b32 v37, 0xffff0000, v152
    v_lshlrev_b32 v38, 16, v153
    v_and_b32 v39, 0xffff0000, v153
    v_add_f32 v32, v32, v36
    v_add_f32 v33, v33, v37
    v_add_f32 v34, v34, v38
    v_add_f32 v35, v35, v39
    v_cvt_pk_bf16_f32 v36, v32, v33
    v_cvt_pk_bf16_f32 v37, v34, v35
    v_lshlrev_b32 v32, 16, v36
    v_and_b32 v33, 0xffff0000, v36
    v_lshlrev_b32 v34, 16, v37
    v_and_b32 v35, 0xffff0000, v37
    v_mul_f32 v36, 0xbfb8aa3b, v32
    v_mul_f32 v37, 0xbfb8aa3b, v33
    v_mul_f32 v38, 0xbfb8aa3b, v34
    v_mul_f32 v39, 0xbfb8aa3b, v35
    v_exp_f32 v36, v36
    v_exp_f32 v37, v37
    v_exp_f32 v38, v38
    v_exp_f32 v39, v39
    v_add_f32 v36, 1.0, v36
    v_add_f32 v37, 1.0, v37
    v_add_f32 v38, 1.0, v38
    v_add_f32 v39, 1.0, v39
    v_rcp_f32 v36, v36
    v_rcp_f32 v37, v37
    v_rcp_f32 v38, v38
    v_rcp_f32 v39, v39
    v_mul_f32 v32, v32, v36
    v_mul_f32 v33, v33, v37
    v_mul_f32 v34, v34, v38
    v_mul_f32 v35, v35, v39
    v_cvt_pk_bf16_f32 v36, v32, v33
    v_cvt_pk_bf16_f32 v37, v34, v35
    v_lshlrev_b32 v32, 16, v36
    v_and_b32 v33, 0xffff0000, v36
    v_lshlrev_b32 v34, 16, v37
    v_and_b32 v35, 0xffff0000, v37
    ds_write_b128 v15, v[32:35]
L_fg:
L_fw_26:
    ds_read_b32 v7, v5 offset:36
    s_waitcnt lgkmcnt(0)
    v_readfirstlane_b32 s100, v7
    s_nop 0
    s_cmp_lt_u32 s100, 4
    s_cbranch_scc1 L_fw_26
    s_mov_b64 s[62:63], -1
    s_mov_b64 s[64:65], -1
    s_mov_b32 s59, 0
L_g_27:
    s_mov_b64 exec, s[62:63]
    s_cbranch_execz L_gs_29
    global_load_dwordx4 v[64:67], v14, s[32:33] offset:0 sc1
L_gs_29:
    s_mov_b64 exec, s[64:65]
    s_cbranch_execz L_gs_30
    global_load_dwordx4 v[68:71], v14, s[32:33] offset:1024 sc1
L_gs_30:
    s_mov_b64 exec, -1
    s_waitcnt vmcnt(0)
    s_mov_b64 s[56:57], 0
    v_perm_b32 v60, v65, v64, s48
    v_perm_b32 v61, v67, v66, s48
    v_perm_b32 v60, v61, v60, s49
    v_cmp_ne_u32 s[54:55], s34, v60
    s_nop 0
    s_and_b64 s[62:63], s[62:63], s[54:55]
    s_or_b64 s[56:57], s[56:57], s[62:63]
    v_perm_b32 v60, v69, v68, s48
    v_perm_b32 v61, v71, v70, s48
    v_perm_b32 v60, v61, v60, s49
    v_cmp_ne_u32 s[54:55], s34, v60
    s_nop 0
    s_and_b64 s[64:65], s[64:65], s[54:55]
    s_or_b64 s[56:57], s[56:57], s[64:65]
    s_add_u32 s59, s59, 1
    s_cmp_ge_u32 s59, 0x40000
    s_cbranch_scc1 L_gd_28
    s_cmp_lg_u64 s[56:57], 0
    s_cbranch_scc1 L_g_27
L_gd_28:
    v_and_b32 v64, 0xffffff00, v64
    v_and_b32 v65, 0xffffff00, v65
    v_and_b32 v66, 0xffffff00, v66
    v_and_b32 v67, 0xffffff00, v67
    v_and_b32 v68, 0xffffff00, v68
    v_and_b32 v69, 0xffffff00, v69
    v_and_b32 v70, 0xffffff00, v70
    v_and_b32 v71, 0xffffff00, v71
    v_add_f32 v32, v64, v68
    v_add_f32 v33, v65, v69
    v_add_f32 v34, v66, v70
    v_add_f32 v35, v67, v71
    v_add_f32_dpp v32, v32, v32 row_ror:8 row_mask:0xf bank_mask:0xf
    v_add_f32_dpp v33, v33, v33 row_ror:8 row_mask:0xf bank_mask:0xf
    v_add_f32_dpp v34, v34, v34 row_ror:8 row_mask:0xf bank_mask:0xf
    v_add_f32_dpp v35, v35, v35 row_ror:8 row_mask:0xf bank_mask:0xf
    v_mov_b32 v36, v32
    v_mov_b32 v37, v33
    v_mov_b32 v38, v34
    v_mov_b32 v39, v35
    v_permlane16_swap_b32 v32, v36
    v_permlane16_swap_b32 v33, v37
    v_permlane16_swap_b32 v34, v38
    v_permlane16_swap_b32 v35, v39
    v_add_f32 v32, v32, v36
    v_add_f32 v33, v33, v37
    v_add_f32 v34, v34, v38
    v_add_f32 v35, v35, v39
    v_mov_b32 v36, v32
    v_mov_b32 v37, v33
    v_mov_b32 v38, v34
    v_mov_b32 v39, v35
    v_permlane32_swap_b32 v32, v36
    v_permlane32_swap_b32 v33, v37
    v_permlane32_swap_b32 v34, v38
    v_permlane32_swap_b32 v35, v39
    v_add_f32 v32, v32, v36
    v_add_f32 v33, v33, v37
    v_add_f32 v34, v34, v38
    v_add_f32 v35, v35, v39
    ds_write_b128 v12, v[32:35] offset:512
    s_waitcnt lgkmcnt(0)
    s_mov_b64 exec, 1
    ds_add_u32 v5, v6 offset:52
    s_mov_b64 exec, -1
    s_cmp_lg_u32 s3, 0
    s_cbranch_scc1 L_dbg_exit
    v_lshlrev_b32 v52, 16, v150
    v_and_b32 v53, 0xffff0000, v150
    v_lshlrev_b32 v54, 16, v151
    v_and_b32 v55, 0xffff0000, v151
L_ffw:
    ds_read_b32 v7, v5 offset:52
    ds_read_b128 v[36:39], v15 offset:768
    ds_read_b128 v[40:43], v15 offset:896
    ds_read_b128 v[44:47], v15 offset:1024
    ds_read_b128 v[48:51], v15
    s_waitcnt lgkmcnt(4)
    v_readfirstlane_b32 s100, v7
    s_nop 0
    s_cmp_lt_u32 s100, 4
    s_cbranch_scc1 L_ffw
    s_waitcnt lgkmcnt(1)
    v_add_f32 v32, v32, v36
    v_add_f32 v40, v40, v44
    v_add_f32 v33, v33, v37
    v_add_f32 v41, v41, v45
    v_add_f32 v34, v34, v38
    v_add_f32 v42, v42, v46
    v_add_f32 v35, v35, v39
    v_add_f32 v43, v43, v47
    v_add_f32 v32, v32, v40
    v_add_f32 v33, v33, v41
    v_add_f32 v34, v34, v42
    v_add_f32 v35, v35, v43
    v_cvt_pk_bf16_f32 v36, v32, v33
    v_cvt_pk_bf16_f32 v37, v34, v35
    v_lshlrev_b32 v32, 16, v36
    v_and_b32 v33, 0xffff0000, v36
    v_lshlrev_b32 v34, 16, v37
    v_and_b32 v35, 0xffff0000, v37
    s_waitcnt lgkmcnt(0)
    v_mul_f32 v32, v32, v48
    v_mul_f32 v33, v33, v49
    v_mul_f32 v34, v34, v50
    v_mul_f32 v35, v35, v51
    v_cvt_pk_bf16_f32 v36, v32, v33
    v_cvt_pk_bf16_f32 v37, v34, v35
    v_lshlrev_b32 v32, 16, v36
    v_and_b32 v33, 0xffff0000, v36
    v_lshlrev_b32 v34, 16, v37
    v_and_b32 v35, 0xffff0000, v37
    v_add_f32 v32, v52, v32
    v_add_f32 v33, v53, v33
    v_add_f32 v34, v54, v34
    v_add_f32 v35, v55, v35
    v_cvt_pk_bf16_f32 v32, v32, v33
    v_cvt_pk_bf16_f32 v33, v34, v35
    s_mov_b64 exec, 0xff
    global_store_dwordx2 v154, v[32:33], s[28:29]
    s_mov_b64 exec, -1
    s_cmp_lg_u32 s2, 0
    s_cbranch_scc1 L_h0_end
    v_mov_b32 v8, 0
    v_mov_b32 v9, s34
    s_mov_b64 exec, 1
    global_store_dword v8, v9, s[32:33]
    s_mov_b64 exec, -1
L_h0_end:
L_dbg_exit:
    s_endpgm
L_worker:
    s_sub_u32 s40, s3, 4
    v_and_b32 v1, 15, v0
    v_lshrrev_b32 v2, 4, v0
    s_bfe_u32 s5, s2, 0x30003
    s_lshr_b32 s56, s2, 6
    s_lshl_b32 s56, s56, 3
    s_and_b32 s4, s2, 7
    s_add_u32 s56, s56, s4
    s_lshl_b32 s56, s56, 5
    s_add_u32 s56, s56, s5
    s_add_u32 s56, s56, 24
    s_lshl_b32 s56, s56, 3
    s_add_u32 s56, s56, s40
    s_lshl_b32 s56, s56, 13
    s_lshl_b32 s41, s40, 13
    v_xor_b32 v3, v1, v2
    v_lshlrev_b32 v8, 8, v2
    v_lshl_add_u32 v8, v3, 4, v8
    s_add_u32 s79, s5, s40
    s_and_b32 s79, s79, 7
    s_and_b32 s57, s79, 3
    s_lshl_b32 s57, s57, 6
    v_xor_b32 v8, s57, v8
    v_xor_b32 v9, 64, v8
    v_xor_b32 v10, 0x80, v8
    v_xor_b32 v11, 0xc0, v8
    s_lshl_b32 s79, s79, 10
    s_mov_b32 s38, 8192
    s_mov_b32 s39, 0x20000
    s_waitcnt lgkmcnt(0)
    s_add_u32 s36, s10, s56
    s_addc_u32 s37, s11, 0
    s_and_b32 s37, s37, 0xffff
    s_barrier
    s_xor_b32 s35, s79, 0
    s_add_u32 m0, s41, s35
    s_nop 0
    buffer_load_dwordx4 v8, s[36:39], s35 offen nt lds
    s_xor_b32 s35, s79, 1024
    s_add_u32 m0, s41, s35
    s_nop 0
    buffer_load_dwordx4 v9, s[36:39], s35 offen nt lds
    s_lshr_b32 s6, s2, 6
    s_and_b32 s7, s2, 63
    v_mov_b32 v5, 130816
    v_mov_b32 v6, 1
    s_setprio 1
    v_lshrrev_b32 v14, 3, v0
    v_and_b32 v15, 7, v0
    s_cmp_gt_u32 s5, 3
    s_subb_u32 s0, s5, 0
    s_cmp_eq_u32 s5, 3
    s_cselect_b32 s0, 7, s0
    s_lshl_b32 s0, s0, 3
    s_add_u32 s0, s0, s4
    s_mul_i32 s1, s6, 56
    s_add_u32 s1, s1, s0
    s_mul_i32 s58, s1, 9363
    s_lshr_b32 s58, s58, 18
    s_mul_i32 s59, s58, 28
    s_sub_u32 s59, s1, s59
    s_lshl_b32 s58, s58, 3
    s_add_u32 s58, s58, s40
    s_mul_i32 s58, s58, 28672
    s_lshl_b32 s59, s59, 7
    s_add_u32 s58, s58, s59
    s_cmp_lt_u32 s0, 56
    s_cselect_b32 s58, s58, 0
    s_cselect_b32 s59, 25216, 0
    v_mul_u32_u24 v12, 3584, v14
    v_lshl_add_u32 v12, v15, 4, v12
    s_lshl_b32 s76, s40, 10
    s_add_u32 s64, s20, s58
    s_addc_u32 s65, s21, 0
    s_and_b32 s65, s65, 0xffff
    s_mov_b32 s66, s59
    s_mov_b32 s67, 0x20000
    s_add_u32 m0, s76, 98304
    s_nop 0
    buffer_load_dwordx4 v12, s[64:67], 0 offen nt lds
    s_waitcnt vmcnt(2)
    s_xor_b32 s35, s79, 2048
    s_add_u32 m0, s41, s35
    s_nop 0
    buffer_load_dwordx4 v10, s[36:39], s35 offen nt lds
    s_add_u32 s52, s12, s56
    s_addc_u32 s53, s13, 0
    s_and_b32 s53, s53, 0xffff
    s_mov_b32 s54, 8192
    s_mov_b32 s55, 0x20000
    s_bfe_u32 s31, s2, 0x20003
    s_bfe_u32 s35, s2, 0x10005
    s_lshl_b32 s35, s35, 4
    s_or_b32 s31, s31, s35
    s_lshl_b32 s78, s31, 8
    s_lshl_b32 s35, s0, 15
    s_lshr_b32 s18, s40, 1
    s_lshl_b32 s18, s18, 13
    s_add_u32 s35, s35, s18
    s_lshl_b32 s18, s6, 8
    s_add_u32 s35, s35, s18
    s_and_b32 s19, s40, 1
    s_lshl_b32 s19, s19, 7
    s_add_u32 s35, s35, s19
    s_cmp_lt_u32 s0, 56
    s_cselect_b32 s35, s35, 0
    s_cselect_b32 s30, 7296, 0
    s_add_u32 s68, s24, s35
    s_addc_u32 s69, s25, 0
    s_and_b32 s69, s69, 0xffff
    s_mov_b32 s70, s30
    s_mov_b32 s71, 0x20000
    v_lshlrev_b32 v165, 10, v14
    v_lshl_add_u32 v165, v15, 4, v165
    s_lshl_b32 s35, s4, 19
    s_lshl_b32 s30, s5, 16
    s_add_u32 s35, s35, s30
    s_lshl_b32 s30, s40, 13
    s_add_u32 s35, s35, s30
    s_add_u32 s35, s35, s18
    s_add_u32 s72, s16, s35
    s_addc_u32 s73, s17, 0
    s_and_b32 s73, s73, 0xffff
    s_mov_b32 s74, 7424
    s_mov_b32 s75, 0x20000
    v_lshlrev_b32 v4, 10, v2
    v_lshl_add_u32 v4, v1, 4, v4
    s_waitcnt vmcnt(2)
    s_xor_b32 s35, s79, 3072
    s_add_u32 m0, s41, s35
    s_nop 0
    buffer_load_dwordx4 v11, s[36:39], s35 offen nt lds
    s_waitcnt vmcnt(2)
    s_mov_b64 exec, 1
    ds_add_u32 v5, v6 offset:8
    s_mov_b64 exec, -1
    s_xor_b32 s35, s79, 4096
    s_add_u32 m0, s41, s35
    s_nop 0
    buffer_load_dwordx4 v8, s[36:39], s35 offen nt lds
    s_waitcnt vmcnt(2)
    s_xor_b32 s35, s79, 5120
    s_add_u32 m0, s41, s35
    s_nop 0
    buffer_load_dwordx4 v9, s[36:39], s35 offen nt lds
    s_waitcnt vmcnt(2)
    s_xor_b32 s35, s79, 6144
    s_add_u32 m0, s41, s35
    s_nop 0
    buffer_load_dwordx4 v10, s[36:39], s35 offen nt lds
    s_waitcnt vmcnt(2)
    s_xor_b32 s35, s79, 7168
    s_add_u32 m0, s41, s35
    s_nop 0
    buffer_load_dwordx4 v11, s[36:39], s35 offen nt lds
    v_and_b32 v3, 1, v1
    v_cmp_eq_u32 vcc, 1, v3
    v_mov_b32 v8, 0xffff
    v_mov_b32 v9, 0xffff0000
    v_cndmask_b32 v11, v8, v9, vcc
    v_bfe_u32 v3, v1, 1, 2
    v_cmp_eq_u32 vcc, 0, v3
    s_nop 1
    v_cndmask_b32 v8, 0, v11, vcc
    v_cmp_eq_u32 vcc, 1, v3
    s_nop 1
    v_cndmask_b32 v9, 0, v11, vcc
    v_cmp_eq_u32 vcc, 2, v3
    s_nop 1
    v_cndmask_b32 v10, 0, v11, vcc
    v_cmp_eq_u32 vcc, 3, v3
    s_nop 1
    v_cndmask_b32 v11, 0, v11, vcc
    s_lshl_b32 s35, s40, 11
    s_add_u32 s35, s35, 65536
    v_lshrrev_b32 v3, 1, v2
    v_lshlrev_b32 v12, 9, v3
    v_lshl_add_u32 v12, v1, 5, v12
    v_and_b32 v3, 1, v2
    v_lshl_add_u32 v12, v3, 4, v12
    v_add_u32 v12, s35, v12
    s_lshr_b32 s18, s40, 1
    s_lshl_b32 s35, s18, 8
    s_add_u32 s35, s35, 128128
    v_lshl_add_u32 v29, v14, 5, s35
    s_lshl_b32 s35, s40, 8
    s_add_u32 s35, s35, 65536
    v_lshl_add_u32 v14, v1, 4, s35
    v_lshl_add_u32 v14, v2, 12, v14
    v_lshrrev_b32 v3, 3, v1
    v_lshlrev_b32 v13, 10, v3
    v_lshl_add_u32 v13, v2, 4, v13
    s_lshl_b32 s35, s40, 7
    s_add_u32 s35, s35, 122880
    v_add_u32 v13, s35, v13
    s_lshl_b32 s35, s18, 4
    s_add_u32 s35, s35, 128000
    v_mov_b32 v15, s35
    s_lshl_b32 s35, s6, 3
    s_add_u32 s35, s35, s4
    s_lshl_b32 s35, s35, 3
    s_add_u32 s35, s35, s40
    s_lshl_b32 s35, s35, 3
    s_add_u32 s35, s35, s5
    s_lshl_b32 s19, s35, 8
    s_add_u32 s19, s19, 1048576
    v_lshl_add_u32 v24, v1, 4, s19
    s_lshl_b32 s19, s6, 3
    s_add_u32 s19, s19, s4
    s_lshl_b32 s19, s19, 10
    s_lshl_b32 s30, s5, 4
    s_add_u32 s19, s19, s30
    s_add_u32 s19, s19, 1572864
    v_and_b32 v3, 7, v0
    v_lshl_add_u32 v25, v3, 7, s19
    v_lshrrev_b32 v3, 1, v3
    v_lshlrev_b32 v27, 4, v3
    v_add_u32 v27, 128000, v27
    s_lshl_b32 s35, s18, 4
    s_lshl_b32 s19, s6, 2
    s_add_u32 s35, s35, s19
    s_and_b32 s19, s40, 1
    s_lshl_b32 s30, s19, 1
    s_add_u32 s35, s35, s30
    s_lshl_b32 s30, s35, 13
    s_lshl_b32 s18, s7, 7
    s_add_u32 s30, s30, s18
    s_add_u32 s30, s30, 2097152
    v_bfe_u32 v3, v1, 2, 1
    v_lshlrev_b32 v26, 13, v3
    v_and_b32 v3, 3, v1
    v_lshl_add_u32 v26, v3, 5, v26
    v_and_b32 v3, 1, v2
    v_lshl_add_u32 v26, v3, 4, v26
    v_add_u32 v26, s30, v26
    s_lshl_b32 s19, s19, 13
    s_add_u32 s19, s19, 81920
    v_lshl_add_u32 v28, v0, 4, s19
    s_waitcnt vmcnt(2)
    s_xor_b32 s35, s78, 0
    buffer_load_dwordx4 v[32:35], v4, s[52:55], s35 offen nt
    s_waitcnt vmcnt(2)
    s_xor_b32 s35, s78, 256
    buffer_load_dwordx4 v[36:39], v4, s[52:55], s35 offen nt
    s_waitcnt vmcnt(2)
    s_mov_b64 exec, 1
    ds_add_u32 v5, v6 offset:16
    s_mov_b64 exec, -1
    s_xor_b32 s35, s78, 512
    buffer_load_dwordx4 v[40:43], v4, s[52:55], s35 offen nt
    s_waitcnt vmcnt(2)
    s_xor_b32 s35, s78, 768
    buffer_load_dwordx4 v[44:47], v4, s[52:55], s35 offen nt
    s_waitcnt vmcnt(2)
    s_xor_b32 s35, s78, 4096
    buffer_load_dwordx4 v[48:51], v4, s[52:55], s35 offen nt
    s_waitcnt vmcnt(2)
    s_xor_b32 s35, s78, 4352
    buffer_load_dwordx4 v[52:55], v4, s[52:55], s35 offen nt
    s_waitcnt vmcnt(2)
    s_xor_b32 s35, s78, 4608
    buffer_load_dwordx4 v[56:59], v4, s[52:55], s35 offen nt
    s_waitcnt vmcnt(2)
    s_xor_b32 s35, s78, 4864
    buffer_load_dwordx4 v[60:63], v4, s[52:55], s35 offen nt
L_fw_31:
    ds_read_b32 v7, v5 offset:20
    s_waitcnt lgkmcnt(0)
    v_readfirstlane_b32 s100, v7
    s_nop 0
    s_cmp_lt_u32 s100, 4
    s_cbranch_scc1 L_fw_31
    ds_read_b32 v3, v5 offset:60
    ds_read_b128 v[16:19], v13
    ds_read_b128 v[20:23], v13 offset:2048
    ds_read_b128 v[160:163], v13 offset:64
    s_waitcnt lgkmcnt(1)
    v_readfirstlane_b32 s34, v3
    v_and_b32 v96, v16, v8
    v_and_b32 v97, v16, v9
    v_and_b32 v98, v16, v10
    v_and_b32 v99, v16, v11
    v_and_b32 v104, v17, v8
    v_and_b32 v105, v17, v9
    v_and_b32 v106, v17, v10
    v_and_b32 v107, v17, v11
    v_and_b32 v112, v18, v8
    v_and_b32 v113, v18, v9
    v_and_b32 v114, v18, v10
    v_and_b32 v115, v18, v11
    v_and_b32 v120, v19, v8
    v_and_b32 v121, v19, v9
    v_and_b32 v122, v19, v10
    v_and_b32 v123, v19, v11
    ds_read_b128 v[16:19], v13 offset:2112
    v_and_b32 v100, v20, v8
    v_and_b32 v101, v20, v9
    v_and_b32 v102, v20, v10
    v_and_b32 v103, v20, v11
    v_and_b32 v108, v21, v8
    v_and_b32 v109, v21, v9
    v_and_b32 v110, v21, v10
    v_and_b32 v111, v21, v11
    v_and_b32 v116, v22, v8
    v_and_b32 v117, v22, v9
    v_and_b32 v118, v22, v10
    v_and_b32 v119, v22, v11
    v_and_b32 v124, v23, v8
    v_and_b32 v125, v23, v9
    v_and_b32 v126, v23, v10
    v_and_b32 v127, v23, v11
    s_waitcnt lgkmcnt(1)
    v_and_b32 v128, v160, v8
    v_and_b32 v129, v160, v9
    v_and_b32 v130, v160, v10
    v_and_b32 v131, v160, v11
    v_and_b32 v136, v161, v8
    v_and_b32 v137, v161, v9
    v_and_b32 v138, v161, v10
    v_and_b32 v139, v161, v11
    v_and_b32 v144, v162, v8
    v_and_b32 v145, v162, v9
    v_and_b32 v146, v162, v10
    v_and_b32 v147, v162, v11
    v_and_b32 v152, v163, v8
    v_and_b32 v153, v163, v9
    v_and_b32 v154, v163, v10
    v_and_b32 v155, v163, v11
    ds_read_b128 v[160:163], v15
    ds_read_b128 v[76:79], v15 offset:64
    s_waitcnt lgkmcnt(2)
    v_and_b32 v132, v16, v8
    v_and_b32 v133, v16, v9
    v_and_b32 v134, v16, v10
    v_and_b32 v135, v16, v11
    v_and_b32 v140, v17, v8
    v_and_b32 v141, v17, v9
    v_and_b32 v142, v17, v10
    v_and_b32 v143, v17, v11
    v_and_b32 v148, v18, v8
    v_and_b32 v149, v18, v9
    v_and_b32 v150, v18, v10
    v_and_b32 v151, v18, v11
    v_and_b32 v156, v19, v8
    v_and_b32 v157, v19, v9
    v_and_b32 v158, v19, v10
    v_and_b32 v159, v19, v11
    s_setprio 2
    s_waitcnt vmcnt(7)
    v_mfma_f32_16x16x32_bf16 v[16:19], v[96:99], v[32:35], 0
    v_mfma_f32_16x16x32_bf16 v[20:23], v[100:103], v[32:35], 0
    s_waitcnt vmcnt(6)
    v_mfma_f32_16x16x32_bf16 v[16:19], v[104:107], v[36:39], v[16:19]
    v_mfma_f32_16x16x32_bf16 v[20:23], v[108:111], v[36:39], v[20:23]
    s_waitcnt vmcnt(5)
    v_mfma_f32_16x16x32_bf16 v[16:19], v[112:115], v[40:43], v[16:19]
    v_mfma_f32_16x16x32_bf16 v[20:23], v[116:119], v[40:43], v[20:23]
    s_waitcnt vmcnt(4)
    v_mfma_f32_16x16x32_bf16 v[16:19], v[120:123], v[44:47], v[16:19]
    v_mfma_f32_16x16x32_bf16 v[20:23], v[124:127], v[44:47], v[20:23]
    s_waitcnt vmcnt(3)
    v_mfma_f32_16x16x32_bf16 v[16:19], v[128:131], v[48:51], v[16:19]
    v_mfma_f32_16x16x32_bf16 v[20:23], v[132:135], v[48:51], v[20:23]
    s_bfe_u32 s44, s34, 0x80000
    s_bfe_u32 s45, s34, 0x80008
    s_bfe_u32 s46, s34, 0x80010
    s_bfe_u32 s47, s34, 0x80018
    v_mov_b32 v164, 0xffffff00
    s_mov_b32 s48, 0x0c0c0400
    s_mov_b32 s49, 0x05040100
    s_waitcnt lgkmcnt(0)
    v_max3_f32 v30, v160, v161, v162
    v_max_f32 v30, v30, v163
    v_sub_f32 v160, v160, v30
    v_sub_f32 v161, v161, v30
    v_sub_f32 v162, v162, v30
    v_sub_f32 v163, v163, v30
    v_mul_f32 v160, 1069066811, v160
    v_mul_f32 v161, 1069066811, v161
    v_mul_f32 v162, 1069066811, v162
    v_mul_f32 v163, 1069066811, v163
    v_exp_f32 v160, v160
    v_exp_f32 v161, v161
    v_exp_f32 v162, v162
    v_exp_f32 v163, v163
    v_mul_f32 v31, v160, v76
    v_fmac_f32 v31, v161, v77
    v_fmac_f32 v31, v162, v78
    v_fmac_f32 v31, v163, v79
    v_cmp_eq_u32 vcc, 1, v2
    s_nop 1
    v_cndmask_b32 v160, v160, v161, vcc
    v_cmp_eq_u32 vcc, 2, v2
    s_nop 1
    v_cndmask_b32 v160, v160, v162, vcc
    v_cmp_eq_u32 vcc, 3, v2
    s_nop 1
    v_cndmask_b32 v160, v160, v163, vcc
    ds_read_b128 v[68:71], v27
    ds_read_b128 v[72:75], v27 offset:64
    s_waitcnt lgkmcnt(0)
    v_max3_f32 v64, v68, v69, v70
    v_max_f32 v64, v64, v71
    v_sub_f32 v68, v68, v64
    v_sub_f32 v69, v69, v64
    v_sub_f32 v70, v70, v64
    v_sub_f32 v71, v71, v64
    v_mul_f32 v68, 1069066811, v68
    v_mul_f32 v69, 1069066811, v69
    v_mul_f32 v70, 1069066811, v70
    v_mul_f32 v71, 1069066811, v71
    v_exp_f32 v68, v68
    v_exp_f32 v69, v69
    v_exp_f32 v70, v70
    v_exp_f32 v71, v71
    v_mul_f32 v66, v68, v72
    v_fmac_f32 v66, v69, v73
    v_fmac_f32 v66, v70, v74
    v_fmac_f32 v66, v71, v75
    v_mov_b32 v65, s34
    v_mov_b32 v67, s34
    s_waitcnt vmcnt(2)
    s_add_u32 m0, s76, 106496
    s_nop 0
    buffer_load_dwordx4 v165, s[68:71], 0 offen nt lds
    v_mfma_f32_16x16x32_bf16 v[16:19], v[136:139], v[52:55], v[16:19]
    v_mfma_f32_16x16x32_bf16 v[20:23], v[140:143], v[52:55], v[20:23]
    s_waitcnt vmcnt(2)
    s_add_u32 m0, s76, 81920
    s_movk_i32 s35, 0
    buffer_load_dwordx4 v165, s[72:75], s35 offen nt lds
    v_mfma_f32_16x16x32_bf16 v[16:19], v[144:147], v[56:59], v[16:19]
    v_mfma_f32_16x16x32_bf16 v[20:23], v[148:151], v[56:59], v[20:23]
    s_waitcnt vmcnt(2)
    v_mfma_f32_16x16x32_bf16 v[16:19], v[152:155], v[60:63], v[16:19]
    v_mfma_f32_16x16x32_bf16 v[20:23], v[156:159], v[60:63], v[20:23]
    s_add_u32 m0, s76, 90112
    s_movk_i32 s35, 128
    buffer_load_dwordx4 v165, s[72:75], s35 offen nt lds
    s_nop 3
    ds_write_b128 v12, v[16:19]
    ds_write_b128 v12, v[20:23] offset:1024
    s_waitcnt lgkmcnt(0)
    s_mov_b64 exec, 1
    ds_add_rtn_u32 v7, v5, v6 offset:40
    s_mov_b64 exec, -1
    s_waitcnt lgkmcnt(0)
    v_readfirstlane_b32 s100, v7
    s_nop 0
    s_cmp_lg_u32 s100, 7
    s_cbranch_scc1 L_notlast
    s_mov_b64 exec, 0xff
    global_store_dwordx4 v25, v[64:67], s[32:33] sc1
    s_mov_b64 exec, -1
L_notlast:
L_op_32:
    ds_read_b32 v7, v5 offset:40
    ds_read_b128 v[96:99], v14
    ds_read_b128 v[100:103], v14 offset:2048
    s_waitcnt lgkmcnt(2)
    v_readfirstlane_b32 s100, v7
    s_nop 0
    s_cmp_lt_u32 s100, 8
    s_cbranch_scc1 L_op_32
    s_waitcnt lgkmcnt(0)
    v_add_f32 v16, v96, v100
    v_add_f32 v17, v97, v101
    v_add_f32 v18, v98, v102
    v_add_f32 v19, v99, v103
    v_mul_f32 v16, v160, v16
    v_mul_f32 v17, v160, v17
    v_mul_f32 v18, v160, v18
    v_mul_f32 v19, v160, v19
    v_mov_b32 v96, v16
    v_mov_b32 v97, v17
    v_mov_b32 v98, v18
    v_mov_b32 v99, v19
    v_permlane16_swap_b32 v16, v96
    v_permlane16_swap_b32 v17, v97
    v_permlane16_swap_b32 v18, v98
    v_permlane16_swap_b32 v19, v99
    v_add_f32 v16, v16, v96
    v_add_f32 v17, v17, v97
    v_add_f32 v18, v18, v98
    v_add_f32 v19, v19, v99
    v_mov_b32 v96, v16
    v_mov_b32 v97, v17
    v_mov_b32 v98, v18
    v_mov_b32 v99, v19
    v_permlane32_swap_b32 v16, v96
    v_permlane32_swap_b32 v17, v97
    v_permlane32_swap_b32 v18, v98
    v_permlane32_swap_b32 v19, v99
    v_add_f32 v16, v16, v96
    v_add_f32 v17, v17, v97
    v_add_f32 v18, v18, v98
    v_add_f32 v19, v19, v99
    v_and_or_b32 v16, v16, v164, s44
    v_and_or_b32 v17, v17, v164, s45
    v_and_or_b32 v18, v18, v164, s46
    v_and_or_b32 v19, v19, v164, s47
    s_mov_b64 exec, 0xffff
    global_store_dwordx4 v24, v[16:19], s[32:33] sc1
    s_mov_b64 exec, -1
    s_waitcnt vmcnt(1)
    s_mov_b64 exec, 1
    ds_add_u32 v5, v6 offset:32
    s_mov_b64 exec, -1
    s_sub_u32 s35, s0, s7
    s_lshl_b32 s35, s35, 7
    s_add_u32 s35, s35, 524288
    v_add_u32 v12, s35, v26
    s_and_b32 s35, s40, 1
    s_lshl_b32 s35, s35, 10
    s_add_u32 s35, s35, 106496
    v_lshl_add_u32 v13, v0, 4, s35
    s_lshr_b32 s35, s40, 1
    s_lshl_b32 s35, s35, 7
    s_add_u32 s35, s35, 129152
    v_lshrrev_b32 v14, 3, v0
    v_lshl_add_u32 v14, v14, 4, s35
L_fw_33:
    ds_read_b32 v7, v5 offset:32
    s_waitcnt lgkmcnt(0)
    v_readfirstlane_b32 s100, v7
    s_nop 0
    s_cmp_lt_u32 s100, 8
    s_cbranch_scc1 L_fw_33
    ds_read_b128 v[64:67], v28 offset:0
    ds_read_b128 v[68:71], v28 offset:1024
    ds_read_b128 v[72:75], v28 offset:2048
    ds_read_b128 v[76:79], v28 offset:3072
    ds_read_b128 v[80:83], v28 offset:4096
    ds_read_b128 v[84:87], v28 offset:5120
    ds_read_b128 v[88:91], v28 offset:6144
    ds_read_b128 v[92:95], v28 offset:7168
    s_cmp_ge_u32 s0, 56
    s_cbranch_scc1 L_noz
    ds_read_b128 v[40:43], v13 offset:0
    ds_read_b128 v[44:47], v13 offset:2048
    ds_read_b128 v[48:51], v13 offset:4096
    ds_read_b128 v[52:55], v13 offset:6144
L_fw_34:
    ds_read_b32 v7, v5 offset:28
    s_waitcnt lgkmcnt(0)
    v_readfirstlane_b32 s100, v7
    s_nop 0
    s_cmp_lt_u32 s100, 1
    s_cbranch_scc1 L_fw_34
    ds_read_b128 v[96:99], v14
    s_waitcnt lgkmcnt(0)
    v_and_b32 v128, v96, v8
    v_and_b32 v129, v96, v9
    v_and_b32 v130, v96, v10
    v_and_b32 v131, v96, v11
    v_and_b32 v132, v97, v8
    v_and_b32 v133, v97, v9
    v_and_b32 v134, v97, v10
    v_and_b32 v135, v97, v11
    v_and_b32 v136, v98, v8
    v_and_b32 v137, v98, v9
    v_and_b32 v138, v98, v10
    v_and_b32 v139, v98, v11
    v_and_b32 v140, v99, v8
    v_and_b32 v141, v99, v9
    v_and_b32 v142, v99, v10
    v_and_b32 v143, v99, v11
    v_mfma_f32_16x16x32_bf16 v[56:59], v[128:131], v[40:43], 0
    v_mfma_f32_16x16x32_bf16 v[56:59], v[132:135], v[44:47], v[56:59]
    v_mfma_f32_16x16x32_bf16 v[56:59], v[136:139], v[48:51], v[56:59]
    v_mfma_f32_16x16x32_bf16 v[56:59], v[140:143], v[52:55], v[56:59]
    s_nop 7
    v_mov_b32 v60, v56
    v_mov_b32 v61, v57
    v_mov_b32 v62, v58
    v_mov_b32 v63, v59
    v_permlane32_swap_b32 v56, v60
    v_permlane32_swap_b32 v57, v61
    v_permlane32_swap_b32 v58, v62
    v_permlane32_swap_b32 v59, v63
    v_add_f32_dpp v56, v60, v56 row_ror:8 row_mask:0xf bank_mask:0xf
    v_add_f32_dpp v57, v61, v57 row_ror:8 row_mask:0xf bank_mask:0xf
    v_add_f32_dpp v58, v62, v58 row_ror:8 row_mask:0xf bank_mask:0xf
    v_add_f32_dpp v59, v63, v59 row_ror:8 row_mask:0xf bank_mask:0xf
    v_and_or_b32 v56, v56, v164, s44
    v_and_or_b32 v57, v57, v164, s45
    v_and_or_b32 v58, v58, v164, s46
    v_and_or_b32 v59, v59, v164, s47
    s_mov_b64 exec, 0x00ff00ff
    global_store_dwordx4 v12, v[56:59], s[32:33] offset:0 sc1
    s_mov_b64 exec, -1
L_noz:
    s_lshr_b32 s35, s40, 1
    s_lshl_b32 s35, s35, 2
    v_add_u32 v3, s35, v5
L_fo_35:
    ds_read_b32 v7, v3 offset:64
    ds_read_b128 v[96:99], v29
    ds_read_b128 v[100:103], v29 offset:16
    s_waitcnt lgkmcnt(2)
    v_readfirstlane_b32 s100, v7
    s_nop 0
    s_cmp_lt_u32 s100, 1
    s_cbranch_scc1 L_fo_35
    s_waitcnt lgkmcnt(0)
    v_and_b32 v128, v96, v8
    v_and_b32 v129, v96, v9
    v_and_b32 v130, v96, v10
    v_and_b32 v131, v96, v11
    v_and_b32 v132, v97, v8
    v_and_b32 v133, v97, v9
    v_and_b32 v134, v97, v10
    v_and_b32 v135, v97, v11
    v_mfma_f32_16x16x32_bf16 v[32:35], v[128:131], v[64:67], 0
    v_and_b32 v136, v98, v8
    v_and_b32 v137, v98, v9
    v_and_b32 v138, v98, v10
    v_and_b32 v139, v98, v11
    v_mfma_f32_16x16x32_bf16 v[32:35], v[132:135], v[68:71], v[32:35]
    v_and_b32 v140, v99, v8
    v_and_b32 v141, v99, v9
    v_and_b32 v142, v99, v10
    v_and_b32 v143, v99, v11
    v_mfma_f32_16x16x32_bf16 v[32:35], v[136:139], v[72:75], v[32:35]
    v_and_b32 v144, v100, v8
    v_and_b32 v145, v100, v9
    v_and_b32 v146, v100, v10
    v_and_b32 v147, v100, v11
    v_mfma_f32_16x16x32_bf16 v[32:35], v[140:143], v[76:79], v[32:35]
    v_and_b32 v148, v101, v8
    v_and_b32 v149, v101, v9
    v_and_b32 v150, v101, v10
    v_and_b32 v151, v101, v11
    v_mfma_f32_16x16x32_bf16 v[32:35], v[144:147], v[80:83], v[32:35]
    v_and_b32 v152, v102, v8
    v_and_b32 v153, v102, v9
    v_and_b32 v154, v102, v10
    v_and_b32 v155, v102, v11
    v_mfma_f32_16x16x32_bf16 v[32:35], v[148:151], v[84:87], v[32:35]
    v_and_b32 v156, v103, v8
    v_and_b32 v157, v103, v9
    v_and_b32 v158, v103, v10
    v_and_b32 v159, v103, v11
    v_mfma_f32_16x16x32_bf16 v[32:35], v[152:155], v[88:91], v[32:35]
    s_nop 0
    v_mfma_f32_16x16x32_bf16 v[32:35], v[156:159], v[92:95], v[32:35]
    s_nop 7
    v_mov_b32 v36, v32
    v_mov_b32 v37, v33
    v_mov_b32 v38, v34
    v_mov_b32 v39, v35
    v_permlane32_swap_b32 v32, v36
    v_permlane32_swap_b32 v33, v37
    v_permlane32_swap_b32 v34, v38
    v_permlane32_swap_b32 v35, v39
    v_add_f32_dpp v32, v36, v32 row_ror:8 row_mask:0xf bank_mask:0xf
    v_add_f32_dpp v33, v37, v33 row_ror:8 row_mask:0xf bank_mask:0xf
    v_add_f32_dpp v34, v38, v34 row_ror:8 row_mask:0xf bank_mask:0xf
    v_add_f32_dpp v35, v39, v35 row_ror:8 row_mask:0xf bank_mask:0xf
    v_and_or_b32 v32, v32, v164, s44
    v_and_or_b32 v33, v33, v164, s45
    v_and_or_b32 v34, v34, v164, s46
    v_and_or_b32 v35, v35, v164, s47
    s_mov_b64 exec, 0x00ff00ff
    global_store_dwordx4 v26, v[32:35], s[32:33] offset:0 sc1
    s_mov_b64 exec, -1
    s_mov_b64 exec, 1
    ds_add_u32 v5, v6 offset:36
    s_mov_b64 exec, -1
    s_endpgm
L_end:
    s_endpgm
.section .rodata,"a"
.p2align 6
.amdhsa_kernel recurrent_scan__sliding_block_cached__mixer_channel_mlp__decode_kernel
  .amdhsa_next_free_vgpr 168
  .amdhsa_next_free_sgpr 102
  .amdhsa_accum_offset 168
  .amdhsa_group_segment_fixed_size 0
  .amdhsa_kernarg_size 104
  .amdhsa_user_sgpr_count 2
  .amdhsa_user_sgpr_kernarg_segment_ptr 1
  .amdhsa_system_sgpr_workgroup_id_x 1
  .amdhsa_float_denorm_mode_32 3
.end_amdhsa_kernel
```
